```python
import torch

def _softmax(x, axis=-1):
    return torch.softmax(x, dim=axis)
def _gelu(x):
    return torch.nn.functional.gelu(x, approximate="tanh")
def _silu(x):
    return torch.nn.functional.silu(x)
def _sigmoid(x):
    return torch.sigmoid(x)
def _layernorm(x, axis=-1, eps=1e-5):
    m = x.mean(dim=axis, keepdim=True)
    v = x.var(dim=axis, keepdim=True, unbiased=False)
    return (x - m) / torch.sqrt(v + eps)
def _scatter_add(tgt, idx, src, axis=0):
    return tgt.clone().index_add_(axis, idx, src)
def _segment_sum(src, seg, n):
    out = torch.zeros((n,) + src.shape[1:], dtype=src.dtype)
    return out.index_add_(0, seg, src)
def _pad(x, pw):
    flat = tuple(v for pair in reversed(pw) for v in pair)
    return torch.nn.functional.pad(x, flat)

kernel_name = 'standalone__seq2seq_rnn_t_joint__speech'

def setup_inputs():

    _w = (lambda a: (lambda t: t.to(torch.bfloat16) if t.is_floating_point() else t)(torch.as_tensor(a)))
    B, T, D, K = 2, 16000, 256, 3
    U = 8
    sc = (1.0 / (K * D)) ** 0.5
    sd = (1.0 / D) ** 0.5
    return {
        "x": _w((lambda *s: torch.randn(*s, dtype=torch.bfloat16) * 0.2)(B, T, D) * 0.5),
        "w1": _w((lambda *s: torch.randn(*s, dtype=torch.bfloat16) * 3.2)(K, D, D) * sc),
        "w2": _w((lambda *s: torch.randn(*s, dtype=torch.bfloat16) * 3.2)(K, D, D) * sc),
        "g": _w((lambda *s: torch.randn(*s, dtype=torch.bfloat16) * 3.2)(B, U, D) * 0.5),
        "w_f": _w((lambda *s: torch.randn(*s, dtype=torch.bfloat16) * 3.2)(D, D) * sd),
        "w_g": _w((lambda *s: torch.randn(*s, dtype=torch.bfloat16) * 3.2)(D, D) * sd),
        "w_o": _w((lambda *s: torch.randn(*s, dtype=torch.bfloat16) * 3.2)(D, D) * sd),
    }

def reference(x, w1, w2, g, w_f, w_g, w_o):
    B, T, D = x.shape
    K = w1.shape[0]
    pad = K // 2
    xp = _pad(x, ((0,0),(pad,pad),(0,0)))
    h = torch.zeros_like(x)
    for i in range(K):
        h = h + torch.einsum("btc,cd->btd", xp[:, i:i+T, :], w1[i])
    h = _gelu(h)[:, ::2, :]
    T1 = h.shape[1]
    hp = _pad(h, ((0,0),(pad,pad),(0,0)))
    f = torch.zeros_like(h)
    for i in range(K):
        f = f + torch.einsum("btc,cd->btd", hp[:, i:i+T1, :], w2[i])
    f = _gelu(f)[:, ::2, :]
    fe = torch.einsum("btd,de->bte", f, w_f)
    ge = torch.einsum("bud,de->bue", g, w_g)
    j = torch.tanh(fe[:, :, None, :] + ge[:, None, :, :])
    return torch.einsum("btud,dv->btuv", j, w_o)
```

```asm
; @launch grid=(252,1,1) block=(512,1,1) lds=161792
.amdgcn_target "amdgcn-amd-amdhsa--gfx950"
.text
.globl standalone__seq2seq_rnn_t_joint__speech_kernel
.p2align 8
.type standalone__seq2seq_rnn_t_joint__speech_kernel,@function
standalone__seq2seq_rnn_t_joint__speech_kernel:
    s_cmp_ge_u32 s2, 252
    s_cbranch_scc1 L_end
    s_load_dwordx16 s[40:55], s[0:1], 0
    v_and_b32 v1, 63, v0
    v_lshrrev_b32 v2, 6, v0
    s_nop 0
    v_readfirstlane_b32 s68, v2
    s_nop 4
    s_and_b32 s56, s68, 3
    s_lshl_b32 s69, s56, 7
    s_lshl_b32 s63, s2, 17
    v_lshrrev_b32 v2, 3, v1
    v_lshlrev_b32 v2, 9, v2
    v_add_u32 v2, s69, v2
    v_and_b32 v3, 7, v1
    v_lshrrev_b32 v4, 2, v1
    v_and_b32 v4, 4, v4
    v_xor_b32 v4, v3, v4
    v_lshl_add_u32 v10, v4, 4, v2
    v_add_u32 v11, 3072, v10
    s_mov_b32 s10, 16384000
    s_mov_b32 s11, 0x20000
    s_mov_b32 s14, 393216
    s_mov_b32 s15, 0x20000
    s_mov_b32 s18, 393216
    s_mov_b32 s19, 0x20000
    s_mov_b32 s22, 8192
    s_mov_b32 s23, 0x20000
    s_mov_b32 s26, 131072
    s_mov_b32 s27, 0x20000
    s_mov_b32 s30, 131072
    s_mov_b32 s31, 0x20000
    s_mov_b32 s34, 131072
    s_mov_b32 s35, 0x20000
    s_mov_b32 s38, 32768000
    s_mov_b32 s39, 0x20000
    s_waitcnt lgkmcnt(0)
    s_mov_b32 s8, s40
    s_and_b32 s9, s41, 0xffff
    s_mov_b32 s12, s42
    s_and_b32 s13, s43, 0xffff
    s_mov_b32 s16, s44
    s_and_b32 s17, s45, 0xffff
    s_mov_b32 s20, s46
    s_and_b32 s21, s47, 0xffff
    s_mov_b32 s24, s48
    s_and_b32 s25, s49, 0xffff
    s_mov_b32 s28, s50
    s_and_b32 s29, s51, 0xffff
    s_mov_b32 s32, s52
    s_and_b32 s33, s53, 0xffff
    s_mov_b32 s36, s54
    s_and_b32 s37, s55, 0xffff
    s_mov_b32 s6, 0x4038aa3b
    s_mov_b32 s7, 0x4038aa3b
    s_mov_b32 s4, 0xc0135761
    s_mov_b32 s5, 0xc0135761
    s_lshr_b32 s48, s2, 3
    s_add_u32 s44, s48, 0
    s_and_b32 s44, s44, 3
    s_lshl_b32 s44, s44, 7
    s_add_u32 s45, s48, 1
    s_and_b32 s45, s45, 3
    s_lshl_b32 s45, s45, 7
    s_add_u32 s46, s48, 2
    s_and_b32 s46, s46, 3
    s_lshl_b32 s46, s46, 7
    s_add_u32 s47, s48, 3
    s_and_b32 s47, s47, 3
    s_lshl_b32 s47, s47, 7
    s_cmp_lt_u32 s68, 4
    s_cbranch_scc1 L_compute
L_helper:
    s_setprio 3
    s_lshl_b32 s57, s56, 12
    s_add_u32 s57, s57, 143392
    s_cmp_ge_u32 s2, 125
    s_cselect_b32 s59, 1, 0
    s_cmp_ge_u32 s2, 250
    s_cbranch_scc1 L_h_setup2
    v_lshlrev_b32 v23, 6, v1
    s_lshl_b32 s67, s48, 2
    s_add_u32 s67, s67, s56
    s_lshl_b32 s67, s67, 12
    v_lshlrev_b32 v38, 6, v1
    s_lshl_b32 s66, s48, 2
    s_add_u32 s66, s66, s56
    s_lshl_b32 s66, s66, 12
    s_and_b32 s66, s66, 524287
    buffer_load_dword v104, v38, s[12:15], s66 offen
    s_mul_i32 s65, s59, 125
    s_sub_u32 s60, s2, s65
    s_lshl_b32 s60, s60, 7
    s_lshl_b32 s65, s56, 3
    s_mul_i32 s68, s59, 16000
    s_lshl_b32 s61, s56, 10
    v_mov_b32 v25, 133
    v_bfrev_b32 v24, 1
    v_lshrrev_b32 v8, 3, v1
    v_add_u32 v2, s65, v8
    v_and_b32 v3, 7, v1
    v_add_u32 v4, 0, v2
    v_bfe_u32 v5, v4, 1, 3
    v_xor_b32 v5, v3, v5
    v_lshlrev_b32 v6, 1, v4
    v_cmp_lt_u32 vcc, 64, v4
    s_nop 1
    v_cndmask_b32 v7, 2, v25, vcc
    v_sub_u32 v6, v6, v7
    v_add_u32 v6, s60, v6
    v_add_u32 v7, s68, v6
    v_lshlrev_b32 v7, 9, v7
    v_lshl_add_u32 v7, v5, 4, v7
    v_cmp_gt_i32 vcc, 0, v6
    s_nop 1
    v_cndmask_b32 v18, v7, v24, vcc
    s_add_u32 m0, s61, 0
    s_nop 0
    buffer_load_dwordx4 v18, s[8:11], s44 offen nt lds
    v_add_u32 v4, 32, v2
    v_bfe_u32 v5, v4, 1, 3
    v_xor_b32 v5, v3, v5
    v_lshlrev_b32 v6, 1, v4
    v_cmp_lt_u32 vcc, 64, v4
    s_nop 1
    v_cndmask_b32 v7, 2, v25, vcc
    v_sub_u32 v6, v6, v7
    v_add_u32 v6, s60, v6
    v_add_u32 v7, s68, v6
    v_lshlrev_b32 v7, 9, v7
    v_lshl_add_u32 v7, v5, 4, v7
    v_cmp_gt_i32 vcc, 0, v6
    s_nop 1
    v_cndmask_b32 v19, v7, v24, vcc
    s_add_u32 m0, s61, 4096
    s_nop 0
    buffer_load_dwordx4 v19, s[8:11], s44 offen nt lds
    v_add_u32 v4, 64, v2
    v_bfe_u32 v5, v4, 1, 3
    v_xor_b32 v5, v3, v5
    v_lshlrev_b32 v6, 1, v4
    v_cmp_lt_u32 vcc, 64, v4
    s_nop 1
    v_cndmask_b32 v7, 2, v25, vcc
    v_sub_u32 v6, v6, v7
    v_add_u32 v6, s60, v6
    v_add_u32 v7, s68, v6
    v_lshlrev_b32 v7, 9, v7
    v_lshl_add_u32 v7, v5, 4, v7
    v_cmp_gt_i32 vcc, 0, v6
    s_nop 1
    v_cndmask_b32 v20, v7, v24, vcc
    s_add_u32 m0, s61, 8192
    s_nop 0
    buffer_load_dwordx4 v20, s[8:11], s44 offen nt lds
    v_add_u32 v4, 96, v2
    v_bfe_u32 v5, v4, 1, 3
    v_xor_b32 v5, v3, v5
    v_lshlrev_b32 v6, 1, v4
    v_cmp_lt_u32 vcc, 64, v4
    s_nop 1
    v_cndmask_b32 v7, 2, v25, vcc
    v_sub_u32 v6, v6, v7
    v_add_u32 v6, s60, v6
    v_add_u32 v7, s68, v6
    v_lshlrev_b32 v7, 9, v7
    v_lshl_add_u32 v7, v5, 4, v7
    v_cmp_gt_i32 vcc, 0, v6
    s_nop 1
    v_cndmask_b32 v21, v7, v24, vcc
    s_add_u32 m0, s61, 12288
    s_nop 0
    buffer_load_dwordx4 v21, s[8:11], s44 offen nt lds
    v_add_u32 v4, 128, v8
    v_bfe_u32 v5, v4, 1, 3
    v_xor_b32 v5, v3, v5
    v_lshlrev_b32 v6, 1, v4
    v_cmp_lt_u32 vcc, 64, v4
    s_nop 1
    v_cndmask_b32 v7, 2, v25, vcc
    v_sub_u32 v6, v6, v7
    v_add_u32 v6, s60, v6
    v_add_u32 v7, s68, v6
    v_lshlrev_b32 v7, 9, v7
    v_lshl_add_u32 v7, v5, 4, v7
    v_cmp_lt_u32 vcc, 130, v4
    s_nop 1
    v_cndmask_b32 v22, v7, v24, vcc
    s_mul_i32 s65, s56, 17408
    s_add_u32 s66, s48, s56
    s_and_b32 s66, s66, 3
    s_lshl_b32 s66, s66, 7
    s_add_u32 m0, s65, 16384
    s_nop 0
    buffer_load_dwordx4 v22, s[8:11], s66 offen nt lds
    s_add_u32 m0, s61, 17408
    s_nop 0
    buffer_load_dwordx4 v18, s[8:11], s45 offen nt lds
    s_add_u32 m0, s61, 21504
    s_nop 0
    buffer_load_dwordx4 v19, s[8:11], s45 offen nt lds
    s_add_u32 m0, s61, 25600
    s_nop 0
    buffer_load_dwordx4 v20, s[8:11], s45 offen nt lds
    s_add_u32 m0, s61, 29696
    s_nop 0
    buffer_load_dwordx4 v21, s[8:11], s45 offen nt lds
    s_waitcnt vmcnt(4)
    s_barrier
    s_add_u32 m0, s61, 34816
    s_nop 0
    buffer_load_dwordx4 v18, s[8:11], s46 offen nt lds
    s_add_u32 m0, s61, 38912
    s_nop 0
    buffer_load_dwordx4 v19, s[8:11], s46 offen nt lds
    s_add_u32 m0, s61, 43008
    s_nop 0
    buffer_load_dwordx4 v20, s[8:11], s46 offen nt lds
    s_add_u32 m0, s61, 47104
    s_nop 0
    buffer_load_dwordx4 v21, s[8:11], s46 offen nt lds
    s_add_u32 m0, s61, 52224
    s_nop 0
    buffer_load_dwordx4 v18, s[8:11], s47 offen nt lds
    s_add_u32 m0, s61, 56320
    s_nop 0
    buffer_load_dwordx4 v19, s[8:11], s47 offen nt lds
    s_add_u32 m0, s61, 60416
    s_nop 0
    buffer_load_dwordx4 v20, s[8:11], s47 offen nt lds
    s_add_u32 m0, s61, 64512
    s_nop 0
    buffer_load_dwordx4 v21, s[8:11], s47 offen nt lds
    s_branch L_h_setup2
L_compute:
    s_cmp_ge_u32 s2, 250
    s_cbranch_scc1 L_end
    s_lshl_b32 s57, s56, 14
    s_add_u32 s57, s57, 69632
    s_lshl_b32 s44, s44, 8
    s_lshl_b32 s45, s45, 8
    s_lshl_b32 s46, s46, 8
    s_lshl_b32 s47, s47, 8
    s_add_u32 m0, s57, 0
    s_add_u32 s58, s44, 0
    buffer_load_dwordx4 v10, s[12:15], s58 offen lds
    buffer_load_dwordx4 v11, s[12:15], s58 offen offset:1024 lds
    s_add_u32 m0, s57, 2048
    s_add_u32 s58, s44, 8192
    buffer_load_dwordx4 v10, s[12:15], s58 offen lds
    buffer_load_dwordx4 v11, s[12:15], s58 offen offset:1024 lds
    v_lshrrev_b32 v2, 4, v1
    v_bfe_u32 v3, v1, 2, 2
    v_and_b32 v4, 3, v1
    v_and_b32 v5, 1, v2
    v_lshl_or_b32 v4, v5, 2, v4
    v_lshrrev_b32 v5, 1, v2
    v_lshlrev_b32 v5, 10, v5
    v_lshl_add_u32 v5, v3, 7, v5
    v_add_u32 v5, s57, v5
    v_lshrrev_b32 v3, 1, v3
    v_and_b32 v8, 1, v4
    v_bfe_u32 v9, v4, 1, 1
    v_lshl_or_b32 v8, v8, 1, v9
    v_and_or_b32 v6, v4, 4, v8
    v_lshlrev_b32 v6, 3, v6
    v_lshl_or_b32 v6, v3, 6, v6
    v_add_u32 v14, v5, v6
    v_xor_b32 v6, 64, v6
    v_add_u32 v15, v5, v6
    v_and_b32 v2, 15, v1
    v_lshrrev_b32 v3, 4, v1
    v_and_b32 v4, 1, v2
    v_lshl_or_b32 v4, v4, 2, v3
    v_and_b32 v8, 1, v4
    v_bfe_u32 v9, v4, 1, 1
    v_lshl_or_b32 v8, v8, 1, v9
    v_and_or_b32 v6, v4, 4, v8
    v_lshlrev_b32 v5, 3, v6
    v_add_u32 v5, s69, v5
    v_mov_b32 v7, 160768
    v_cmp_gt_u32 vcc, 2, v2
    s_nop 1
    v_cndmask_b32 v43, v7, v5, vcc
    v_mov_b32 v48, 0
    s_lshl_b32 s65, s56, 13
    s_add_u32 s65, s65, 36864
    v_lshlrev_b32 v5, 4, v1
    v_add_u32 v53, s65, v5
    s_lshl_b32 s65, s56, 12
    s_add_u32 s65, s65, 143392
    v_add_u32 v52, s65, v5
    v_and_b32 v2, 31, v1
    v_lshrrev_b32 v3, 5, v1
    v_add_u32 v6, 66, v2
    v_bfe_u32 v7, v6, 1, 3
    v_xor_b32 v7, v3, v7
    v_lshlrev_b32 v6, 7, v6
    v_lshl_add_u32 v18, v7, 4, v6
    v_xor_b32 v19, 32, v18
    v_xor_b32 v20, 64, v18
    v_xor_b32 v21, 96, v18
    v_add_u32 v6, 1, v2
    v_bfe_u32 v7, v6, 1, 3
    v_xor_b32 v7, v3, v7
    v_lshlrev_b32 v6, 7, v6
    v_lshl_add_u32 v22, v7, 4, v6
    v_xor_b32 v23, 32, v22
    v_xor_b32 v24, 64, v22
    v_xor_b32 v25, 96, v22
    v_add_u32 v6, 67, v2
    v_bfe_u32 v7, v6, 1, 3
    v_xor_b32 v7, v3, v7
    v_lshlrev_b32 v6, 7, v6
    v_lshl_add_u32 v26, v7, 4, v6
    v_xor_b32 v27, 32, v26
    v_xor_b32 v28, 64, v26
    v_xor_b32 v29, 96, v26
    v_mul_u32_u24 v4, 528, v2
    v_lshl_add_u32 v44, v3, 4, v4
    v_add_u32 v45, s69, v44
    v_and_b32 v4, 1, v2
    v_cmp_eq_u32 vcc, 1, v4
    v_mov_b32 v5, 1
    s_nop 0
    v_cndmask_b32 v5, 37, v5, vcc
    v_lshrrev_b32 v4, 1, v2
    v_add_u32 v4, v4, v5
    v_mul_u32_u24 v4, 528, v4
    v_lshl_add_u32 v4, v3, 4, v4
    v_add_u32 v42, s69, v4
    v_mul_u32_u24 v4, 1040, v2
    v_lshl_add_u32 v4, v3, 4, v4
    v_add_u32 v46, s69, v4
    v_and_b32 v8, 15, v1
    v_lshrrev_b32 v9, 4, v1
    v_and_b32 v4, 1, v9
    v_lshrrev_b32 v5, 1, v9
    v_mov_b32 v47, 133
    v_cmp_eq_u32 vcc, v8, v4
    v_mov_b32 v7, 65
    s_nop 0
    v_cndmask_b32 v6, v47, v7, vcc
    v_bfe_u32 v7, v6, 1, 3
    v_xor_b32 v7, v5, v7
    v_lshlrev_b32 v6, 7, v6
    v_lshl_add_u32 v30, v7, 4, v6
    v_xor_b32 v31, 32, v30
    v_xor_b32 v32, 64, v30
    v_xor_b32 v33, 96, v30
    v_mov_b32 v7, 0
    v_cndmask_b32 v6, v47, v7, vcc
    v_bfe_u32 v7, v6, 1, 3
    v_xor_b32 v7, v5, v7
    v_lshlrev_b32 v6, 7, v6
    v_lshl_add_u32 v34, v7, 4, v6
    v_xor_b32 v35, 32, v34
    v_xor_b32 v36, 64, v34
    v_xor_b32 v37, 96, v34
    v_mov_b32 v7, 66
    v_cndmask_b32 v6, v47, v7, vcc
    v_bfe_u32 v7, v6, 1, 3
    v_xor_b32 v7, v5, v7
    v_lshlrev_b32 v6, 7, v6
    v_lshl_add_u32 v38, v7, 4, v6
    v_xor_b32 v39, 32, v38
    v_xor_b32 v40, 64, v38
    v_xor_b32 v41, 96, v38
    v_mov_b32 v54, 0xbdd2d3e8
    v_mov_b32 v55, 0xbdd2d3e8
    s_add_u32 m0, s57, 4096
    s_add_u32 s58, s44, 16384
    buffer_load_dwordx4 v10, s[12:15], s58 offen lds
    buffer_load_dwordx4 v11, s[12:15], s58 offen offset:1024 lds
    s_add_u32 m0, s57, 6144
    s_add_u32 s58, s44, 24576
    buffer_load_dwordx4 v10, s[12:15], s58 offen lds
    buffer_load_dwordx4 v11, s[12:15], s58 offen offset:1024 lds
    s_add_u32 m0, s57, 8192
    s_add_u32 s58, s44, 131072
    buffer_load_dwordx4 v10, s[12:15], s58 offen lds
    buffer_load_dwordx4 v11, s[12:15], s58 offen offset:1024 lds
    s_add_u32 m0, s57, 10240
    s_add_u32 s58, s44, 139264
    buffer_load_dwordx4 v10, s[12:15], s58 offen lds
    buffer_load_dwordx4 v11, s[12:15], s58 offen offset:1024 lds
    s_add_u32 m0, s57, 12288
    s_add_u32 s58, s44, 147456
    buffer_load_dwordx4 v10, s[12:15], s58 offen lds
    buffer_load_dwordx4 v11, s[12:15], s58 offen offset:1024 lds
    s_add_u32 m0, s57, 14336
    s_add_u32 s58, s44, 155648
    buffer_load_dwordx4 v10, s[12:15], s58 offen lds
    buffer_load_dwordx4 v11, s[12:15], s58 offen offset:1024 lds
    s_waitcnt vmcnt(14)
    ds_read_b64_tr_b16 a[0:1], v14
    ds_read_b64_tr_b16 a[2:3], v14 offset:512
    ds_read_b64_tr_b16 a[4:5], v15
    ds_read_b64_tr_b16 a[6:7], v15 offset:512
    s_barrier
    ds_read_b128 a[64:67], v18
    ds_read_b128 a[68:71], v18 offset:4096
    ds_read_b128 a[72:75], v30
    s_waitcnt lgkmcnt(2)
    v_mfma_f32_32x32x16_bf16 v[56:71], a[0:3], a[64:67], 0
    ds_read_b128 a[76:79], v19
    ds_read_b128 a[80:83], v19 offset:4096
    ds_read_b128 a[84:87], v31
    v_mfma_f32_32x32x16_bf16 v[88:103], a[4:7], a[64:67], 0
    s_waitcnt lgkmcnt(4)
    v_mfma_f32_32x32x16_bf16 v[72:87], a[0:3], a[68:71], 0
    v_mfma_f32_32x32x16_bf16 v[104:119], a[4:7], a[68:71], 0
    s_waitcnt lgkmcnt(3)
    v_mfma_f32_16x16x32_bf16 v[120:123], a[0:3], a[72:75], 0
    v_mfma_f32_16x16x32_bf16 v[124:127], a[4:7], a[72:75], 0
    s_waitcnt vmcnt(12)
    ds_read_b64_tr_b16 a[8:9], v14 offset:2048
    ds_read_b64_tr_b16 a[10:11], v14 offset:2560
    ds_read_b64_tr_b16 a[12:13], v15 offset:2048
    ds_read_b64_tr_b16 a[14:15], v15 offset:2560
    s_waitcnt lgkmcnt(2)
    v_mfma_f32_32x32x16_bf16 v[56:71], a[8:11], a[76:79], v[56:71]
    ds_read_b128 a[64:67], v20
    ds_read_b128 a[68:71], v20 offset:4096
    ds_read_b128 a[72:75], v32
    s_waitcnt lgkmcnt(3)
    v_mfma_f32_32x32x16_bf16 v[88:103], a[12:15], a[76:79], v[88:103]
    s_add_u32 m0, s57, 0
    s_add_u32 s58, s44, 262144
    buffer_load_dwordx4 v10, s[12:15], s58 offen lds
    buffer_load_dwordx4 v11, s[12:15], s58 offen offset:1024 lds
    v_mfma_f32_32x32x16_bf16 v[72:87], a[8:11], a[80:83], v[72:87]
    v_mfma_f32_32x32x16_bf16 v[104:119], a[12:15], a[80:83], v[104:119]
    v_mfma_f32_16x16x32_bf16 v[120:123], a[8:11], a[84:87], v[120:123]
    v_mfma_f32_16x16x32_bf16 v[124:127], a[12:15], a[84:87], v[124:127]
    s_waitcnt vmcnt(12)
    ds_read_b64_tr_b16 a[16:17], v14 offset:4096
    ds_read_b64_tr_b16 a[18:19], v14 offset:4608
    ds_read_b64_tr_b16 a[20:21], v15 offset:4096
    ds_read_b64_tr_b16 a[22:23], v15 offset:4608
    s_waitcnt lgkmcnt(2)
    v_mfma_f32_32x32x16_bf16 v[56:71], a[16:19], a[64:67], v[56:71]
    ds_read_b128 a[76:79], v21
    ds_read_b128 a[80:83], v21 offset:4096
    ds_read_b128 a[84:87], v33
    s_waitcnt lgkmcnt(3)
    v_mfma_f32_32x32x16_bf16 v[88:103], a[20:23], a[64:67], v[88:103]
    s_add_u32 m0, s57, 2048
    s_add_u32 s58, s44, 270336
    buffer_load_dwordx4 v10, s[12:15], s58 offen lds
    buffer_load_dwordx4 v11, s[12:15], s58 offen offset:1024 lds
    v_mfma_f32_32x32x16_bf16 v[72:87], a[16:19], a[68:71], v[72:87]
    v_mfma_f32_32x32x16_bf16 v[104:119], a[20:23], a[68:71], v[104:119]
    v_mfma_f32_16x16x32_bf16 v[120:123], a[16:19], a[72:75], v[120:123]
    v_mfma_f32_16x16x32_bf16 v[124:127], a[20:23], a[72:75], v[124:127]
    s_waitcnt vmcnt(12)
    ds_read_b64_tr_b16 a[24:25], v14 offset:6144
    ds_read_b64_tr_b16 a[26:27], v14 offset:6656
    ds_read_b64_tr_b16 a[28:29], v15 offset:6144
    ds_read_b64_tr_b16 a[30:31], v15 offset:6656
    s_waitcnt lgkmcnt(2)
    v_mfma_f32_32x32x16_bf16 v[56:71], a[24:27], a[76:79], v[56:71]
    ds_read_b128 a[64:67], v22
    ds_read_b128 a[68:71], v22 offset:4096
    ds_read_b128 a[72:75], v34
    s_waitcnt lgkmcnt(3)
    v_mfma_f32_32x32x16_bf16 v[88:103], a[28:31], a[76:79], v[88:103]
    s_add_u32 m0, s57, 4096
    s_add_u32 s58, s44, 278528
    buffer_load_dwordx4 v10, s[12:15], s58 offen lds
    buffer_load_dwordx4 v11, s[12:15], s58 offen offset:1024 lds
    v_mfma_f32_32x32x16_bf16 v[72:87], a[24:27], a[80:83], v[72:87]
    v_mfma_f32_32x32x16_bf16 v[104:119], a[28:31], a[80:83], v[104:119]
    v_mfma_f32_16x16x32_bf16 v[120:123], a[24:27], a[84:87], v[120:123]
    v_mfma_f32_16x16x32_bf16 v[124:127], a[28:31], a[84:87], v[124:127]
    s_waitcnt vmcnt(12)
    ds_read_b64_tr_b16 a[32:33], v14 offset:8192
    ds_read_b64_tr_b16 a[34:35], v14 offset:8704
    ds_read_b64_tr_b16 a[36:37], v15 offset:8192
    ds_read_b64_tr_b16 a[38:39], v15 offset:8704
    s_waitcnt lgkmcnt(2)
    v_mfma_f32_32x32x16_bf16 v[56:71], a[32:35], a[64:67], v[56:71]
    ds_read_b128 a[76:79], v23
    ds_read_b128 a[80:83], v23 offset:4096
    ds_read_b128 a[84:87], v35
    s_waitcnt lgkmcnt(3)
    v_mfma_f32_32x32x16_bf16 v[88:103], a[36:39], a[64:67], v[88:103]
    s_add_u32 m0, s57, 6144
    s_add_u32 s58, s44, 286720
    buffer_load_dwordx4 v10, s[12:15], s58 offen lds
    buffer_load_dwordx4 v11, s[12:15], s58 offen offset:1024 lds
    v_mfma_f32_32x32x16_bf16 v[72:87], a[32:35], a[68:71], v[72:87]
    s_waitcnt vmcnt(12)
    ds_read_b64_tr_b16 a[40:41], v14 offset:10240
    ds_read_b64_tr_b16 a[42:43], v14 offset:10752
    ds_read_b64_tr_b16 a[44:45], v15 offset:10240
    ds_read_b64_tr_b16 a[46:47], v15 offset:10752
    v_mfma_f32_32x32x16_bf16 v[104:119], a[36:39], a[68:71], v[104:119]
    v_mfma_f32_16x16x32_bf16 v[120:123], a[32:35], a[72:75], v[120:123]
    v_mfma_f32_16x16x32_bf16 v[124:127], a[36:39], a[72:75], v[124:127]
    s_waitcnt lgkmcnt(2)
    v_mfma_f32_32x32x16_bf16 v[56:71], a[40:43], a[76:79], v[56:71]
    ds_read_b128 a[64:67], v24
    ds_read_b128 a[68:71], v24 offset:4096
    ds_read_b128 a[72:75], v36
    s_waitcnt lgkmcnt(3)
    v_mfma_f32_32x32x16_bf16 v[88:103], a[44:47], a[76:79], v[88:103]
    s_waitcnt vmcnt(10)
    ds_read_b64_tr_b16 a[48:49], v14 offset:12288
    ds_read_b64_tr_b16 a[50:51], v14 offset:12800
    ds_read_b64_tr_b16 a[52:53], v15 offset:12288
    ds_read_b64_tr_b16 a[54:55], v15 offset:12800
    v_mfma_f32_32x32x16_bf16 v[72:87], a[40:43], a[80:83], v[72:87]
    s_add_u32 m0, s57, 8192
    s_add_u32 s58, s45, 0
    buffer_load_dwordx4 v10, s[12:15], s58 offen lds
    buffer_load_dwordx4 v11, s[12:15], s58 offen offset:1024 lds
    v_mfma_f32_32x32x16_bf16 v[104:119], a[44:47], a[80:83], v[104:119]
    v_mfma_f32_16x16x32_bf16 v[120:123], a[40:43], a[84:87], v[120:123]
    v_mfma_f32_16x16x32_bf16 v[124:127], a[44:47], a[84:87], v[124:127]
    s_waitcnt lgkmcnt(2)
    v_mfma_f32_32x32x16_bf16 v[56:71], a[48:51], a[64:67], v[56:71]
    ds_read_b128 a[76:79], v25
    ds_read_b128 a[80:83], v25 offset:4096
    ds_read_b128 a[84:87], v37
    s_waitcnt lgkmcnt(3)
    v_mfma_f32_32x32x16_bf16 v[88:103], a[52:55], a[64:67], v[88:103]
    s_waitcnt vmcnt(10)
    ds_read_b64_tr_b16 a[56:57], v14 offset:14336
    ds_read_b64_tr_b16 a[58:59], v14 offset:14848
    ds_read_b64_tr_b16 a[60:61], v15 offset:14336
    ds_read_b64_tr_b16 a[62:63], v15 offset:14848
    v_mfma_f32_32x32x16_bf16 v[72:87], a[48:51], a[68:71], v[72:87]
    s_add_u32 m0, s57, 10240
    s_add_u32 s58, s45, 8192
    buffer_load_dwordx4 v10, s[12:15], s58 offen lds
    buffer_load_dwordx4 v11, s[12:15], s58 offen offset:1024 lds
    v_mfma_f32_32x32x16_bf16 v[104:119], a[52:55], a[68:71], v[104:119]
    v_mfma_f32_16x16x32_bf16 v[120:123], a[48:51], a[72:75], v[120:123]
    v_mfma_f32_16x16x32_bf16 v[124:127], a[52:55], a[72:75], v[124:127]
    s_waitcnt lgkmcnt(2)
    v_mfma_f32_32x32x16_bf16 v[56:71], a[56:59], a[76:79], v[56:71]
    ds_read_b128 a[64:67], v26
    ds_read_b128 a[68:71], v26 offset:4096
    ds_read_b128 a[72:75], v38
    s_waitcnt lgkmcnt(3)
    v_mfma_f32_32x32x16_bf16 v[88:103], a[60:63], a[76:79], v[88:103]
    s_waitcnt vmcnt(10)
    ds_read_b64_tr_b16 a[0:1], v14
    ds_read_b64_tr_b16 a[2:3], v14 offset:512
    ds_read_b64_tr_b16 a[4:5], v15
    ds_read_b64_tr_b16 a[6:7], v15 offset:512
    v_mfma_f32_32x32x16_bf16 v[72:87], a[56:59], a[80:83], v[72:87]
    s_add_u32 m0, s57, 12288
    s_add_u32 s58, s45, 16384
    buffer_load_dwordx4 v10, s[12:15], s58 offen lds
    buffer_load_dwordx4 v11, s[12:15], s58 offen offset:1024 lds
    v_mfma_f32_32x32x16_bf16 v[104:119], a[60:63], a[80:83], v[104:119]
    v_mfma_f32_16x16x32_bf16 v[120:123], a[56:59], a[84:87], v[120:123]
    v_mfma_f32_16x16x32_bf16 v[124:127], a[60:63], a[84:87], v[124:127]
    s_waitcnt lgkmcnt(2)
    v_mfma_f32_32x32x16_bf16 v[56:71], a[0:3], a[64:67], v[56:71]
    ds_read_b128 a[76:79], v27
    ds_read_b128 a[80:83], v27 offset:4096
    ds_read_b128 a[84:87], v39
    s_waitcnt lgkmcnt(3)
    v_mfma_f32_32x32x16_bf16 v[88:103], a[4:7], a[64:67], v[88:103]
    s_waitcnt vmcnt(10)
    ds_read_b64_tr_b16 a[8:9], v14 offset:2048
    ds_read_b64_tr_b16 a[10:11], v14 offset:2560
    ds_read_b64_tr_b16 a[12:13], v15 offset:2048
    ds_read_b64_tr_b16 a[14:15], v15 offset:2560
    v_mfma_f32_32x32x16_bf16 v[72:87], a[0:3], a[68:71], v[72:87]
    s_add_u32 m0, s57, 14336
    s_add_u32 s58, s45, 24576
    buffer_load_dwordx4 v10, s[12:15], s58 offen lds
    buffer_load_dwordx4 v11, s[12:15], s58 offen offset:1024 lds
    v_mfma_f32_32x32x16_bf16 v[104:119], a[4:7], a[68:71], v[104:119]
    v_mfma_f32_16x16x32_bf16 v[120:123], a[0:3], a[72:75], v[120:123]
    v_mfma_f32_16x16x32_bf16 v[124:127], a[4:7], a[72:75], v[124:127]
    s_waitcnt lgkmcnt(2)
    v_mfma_f32_32x32x16_bf16 v[56:71], a[8:11], a[76:79], v[56:71]
    ds_read_b128 a[64:67], v28
    ds_read_b128 a[68:71], v28 offset:4096
    ds_read_b128 a[72:75], v40
    s_waitcnt lgkmcnt(3)
    v_mfma_f32_32x32x16_bf16 v[88:103], a[12:15], a[76:79], v[88:103]
    s_waitcnt vmcnt(10)
    ds_read_b64_tr_b16 a[16:17], v14 offset:4096
    ds_read_b64_tr_b16 a[18:19], v14 offset:4608
    ds_read_b64_tr_b16 a[20:21], v15 offset:4096
    ds_read_b64_tr_b16 a[22:23], v15 offset:4608
    v_mfma_f32_32x32x16_bf16 v[72:87], a[8:11], a[80:83], v[72:87]
    s_add_u32 m0, s57, 0
    s_add_u32 s58, s45, 131072
    buffer_load_dwordx4 v10, s[12:15], s58 offen lds
    buffer_load_dwordx4 v11, s[12:15], s58 offen offset:1024 lds
    v_mfma_f32_32x32x16_bf16 v[104:119], a[12:15], a[80:83], v[104:119]
    v_mfma_f32_16x16x32_bf16 v[120:123], a[8:11], a[84:87], v[120:123]
    v_mfma_f32_16x16x32_bf16 v[124:127], a[12:15], a[84:87], v[124:127]
    s_waitcnt lgkmcnt(2)
    v_mfma_f32_32x32x16_bf16 v[56:71], a[16:19], a[64:67], v[56:71]
    ds_read_b128 a[76:79], v29
    ds_read_b128 a[80:83], v29 offset:4096
    ds_read_b128 a[84:87], v41
    s_waitcnt lgkmcnt(3)
    v_mfma_f32_32x32x16_bf16 v[88:103], a[20:23], a[64:67], v[88:103]
    s_waitcnt vmcnt(10)
    ds_read_b64_tr_b16 a[24:25], v14 offset:6144
    ds_read_b64_tr_b16 a[26:27], v14 offset:6656
    ds_read_b64_tr_b16 a[28:29], v15 offset:6144
    ds_read_b64_tr_b16 a[30:31], v15 offset:6656
    v_mfma_f32_32x32x16_bf16 v[72:87], a[16:19], a[68:71], v[72:87]
    s_add_u32 m0, s57, 2048
    s_add_u32 s58, s45, 139264
    buffer_load_dwordx4 v10, s[12:15], s58 offen lds
    buffer_load_dwordx4 v11, s[12:15], s58 offen offset:1024 lds
    v_mfma_f32_32x32x16_bf16 v[104:119], a[20:23], a[68:71], v[104:119]
    v_mfma_f32_16x16x32_bf16 v[120:123], a[16:19], a[72:75], v[120:123]
    v_mfma_f32_16x16x32_bf16 v[124:127], a[20:23], a[72:75], v[124:127]
    s_waitcnt lgkmcnt(2)
    v_mfma_f32_32x32x16_bf16 v[56:71], a[24:27], a[76:79], v[56:71]
    s_waitcnt lgkmcnt(0)
    v_mfma_f32_32x32x16_bf16 v[88:103], a[28:31], a[76:79], v[88:103]
    s_waitcnt vmcnt(10)
    ds_read_b64_tr_b16 a[32:33], v14 offset:8192
    ds_read_b64_tr_b16 a[34:35], v14 offset:8704
    ds_read_b64_tr_b16 a[36:37], v15 offset:8192
    ds_read_b64_tr_b16 a[38:39], v15 offset:8704
    v_mfma_f32_32x32x16_bf16 v[72:87], a[24:27], a[80:83], v[72:87]
    s_add_u32 m0, s57, 4096
    s_add_u32 s58, s45, 147456
    buffer_load_dwordx4 v10, s[12:15], s58 offen lds
    buffer_load_dwordx4 v11, s[12:15], s58 offen offset:1024 lds
    v_mfma_f32_32x32x16_bf16 v[104:119], a[28:31], a[80:83], v[104:119]
    v_mfma_f32_16x16x32_bf16 v[120:123], a[24:27], a[84:87], v[120:123]
    v_mfma_f32_16x16x32_bf16 v[124:127], a[28:31], a[84:87], v[124:127]
    s_barrier
    ds_read_b128 a[64:67], v18 offset:17408
    ds_read_b128 a[68:71], v18 offset:21504
    ds_read_b128 a[72:75], v30 offset:17408
    s_waitcnt lgkmcnt(2)
    v_mfma_f32_32x32x16_bf16 v[56:71], a[32:35], a[64:67], v[56:71]
    ds_read_b128 a[76:79], v19 offset:17408
    ds_read_b128 a[80:83], v19 offset:21504
    ds_read_b128 a[84:87], v31 offset:17408
    v_mfma_f32_32x32x16_bf16 v[88:103], a[36:39], a[64:67], v[88:103]
    s_waitcnt vmcnt(10)
    ds_read_b64_tr_b16 a[40:41], v14 offset:10240
    ds_read_b64_tr_b16 a[42:43], v14 offset:10752
    ds_read_b64_tr_b16 a[44:45], v15 offset:10240
    ds_read_b64_tr_b16 a[46:47], v15 offset:10752
    s_waitcnt lgkmcnt(8)
    v_mfma_f32_32x32x16_bf16 v[72:87], a[32:35], a[68:71], v[72:87]
    s_add_u32 m0, s57, 6144
    s_add_u32 s58, s45, 155648
    buffer_load_dwordx4 v10, s[12:15], s58 offen lds
    buffer_load_dwordx4 v11, s[12:15], s58 offen offset:1024 lds
    v_mfma_f32_32x32x16_bf16 v[104:119], a[36:39], a[68:71], v[104:119]
    s_waitcnt lgkmcnt(7)
    v_mfma_f32_16x16x32_bf16 v[120:123], a[32:35], a[72:75], v[120:123]
    v_mfma_f32_16x16x32_bf16 v[124:127], a[36:39], a[72:75], v[124:127]
    s_waitcnt lgkmcnt(2)
    v_mfma_f32_32x32x16_bf16 v[56:71], a[40:43], a[76:79], v[56:71]
    ds_read_b128 a[64:67], v20 offset:17408
    ds_read_b128 a[68:71], v20 offset:21504
    ds_read_b128 a[72:75], v32 offset:17408
    s_waitcnt lgkmcnt(3)
    v_mfma_f32_32x32x16_bf16 v[88:103], a[44:47], a[76:79], v[88:103]
    s_waitcnt vmcnt(10)
    ds_read_b64_tr_b16 a[48:49], v14 offset:12288
    ds_read_b64_tr_b16 a[50:51], v14 offset:12800
    ds_read_b64_tr_b16 a[52:53], v15 offset:12288
    ds_read_b64_tr_b16 a[54:55], v15 offset:12800
    v_mfma_f32_32x32x16_bf16 v[72:87], a[40:43], a[80:83], v[72:87]
    s_add_u32 m0, s57, 8192
    s_add_u32 s58, s45, 262144
    buffer_load_dwordx4 v10, s[12:15], s58 offen lds
    buffer_load_dwordx4 v11, s[12:15], s58 offen offset:1024 lds
    v_mfma_f32_32x32x16_bf16 v[104:119], a[44:47], a[80:83], v[104:119]
    v_mfma_f32_16x16x32_bf16 v[120:123], a[40:43], a[84:87], v[120:123]
    v_mfma_f32_16x16x32_bf16 v[124:127], a[44:47], a[84:87], v[124:127]
    s_waitcnt lgkmcnt(2)
    v_mfma_f32_32x32x16_bf16 v[56:71], a[48:51], a[64:67], v[56:71]
    ds_read_b128 a[76:79], v21 offset:17408
    ds_read_b128 a[80:83], v21 offset:21504
    ds_read_b128 a[84:87], v33 offset:17408
    s_waitcnt lgkmcnt(3)
    v_mfma_f32_32x32x16_bf16 v[88:103], a[52:55], a[64:67], v[88:103]
    s_waitcnt vmcnt(10)
    ds_read_b64_tr_b16 a[56:57], v14 offset:14336
    ds_read_b64_tr_b16 a[58:59], v14 offset:14848
    ds_read_b64_tr_b16 a[60:61], v15 offset:14336
    ds_read_b64_tr_b16 a[62:63], v15 offset:14848
    v_mfma_f32_32x32x16_bf16 v[72:87], a[48:51], a[68:71], v[72:87]
    s_add_u32 m0, s57, 10240
    s_add_u32 s58, s45, 270336
    buffer_load_dwordx4 v10, s[12:15], s58 offen lds
    buffer_load_dwordx4 v11, s[12:15], s58 offen offset:1024 lds
    v_mfma_f32_32x32x16_bf16 v[104:119], a[52:55], a[68:71], v[104:119]
    v_mfma_f32_16x16x32_bf16 v[120:123], a[48:51], a[72:75], v[120:123]
    v_mfma_f32_16x16x32_bf16 v[124:127], a[52:55], a[72:75], v[124:127]
    s_waitcnt lgkmcnt(2)
    v_mfma_f32_32x32x16_bf16 v[56:71], a[56:59], a[76:79], v[56:71]
    ds_read_b128 a[64:67], v22 offset:17408
    ds_read_b128 a[68:71], v22 offset:21504
    ds_read_b128 a[72:75], v34 offset:17408
    s_waitcnt lgkmcnt(3)
    v_mfma_f32_32x32x16_bf16 v[88:103], a[60:63], a[76:79], v[88:103]
    s_waitcnt vmcnt(10)
    ds_read_b64_tr_b16 a[0:1], v14
    ds_read_b64_tr_b16 a[2:3], v14 offset:512
    ds_read_b64_tr_b16 a[4:5], v15
    ds_read_b64_tr_b16 a[6:7], v15 offset:512
    v_mfma_f32_32x32x16_bf16 v[72:87], a[56:59], a[80:83], v[72:87]
    s_add_u32 m0, s57, 12288
    s_add_u32 s58, s45, 278528
    buffer_load_dwordx4 v10, s[12:15], s58 offen lds
    buffer_load_dwordx4 v11, s[12:15], s58 offen offset:1024 lds
    v_mfma_f32_32x32x16_bf16 v[104:119], a[60:63], a[80:83], v[104:119]
    v_mfma_f32_16x16x32_bf16 v[120:123], a[56:59], a[84:87], v[120:123]
    v_mfma_f32_16x16x32_bf16 v[124:127], a[60:63], a[84:87], v[124:127]
    s_waitcnt lgkmcnt(2)
    v_mfma_f32_32x32x16_bf16 v[56:71], a[0:3], a[64:67], v[56:71]
    ds_read_b128 a[76:79], v23 offset:17408
    ds_read_b128 a[80:83], v23 offset:21504
    ds_read_b128 a[84:87], v35 offset:17408
    s_waitcnt lgkmcnt(3)
    v_mfma_f32_32x32x16_bf16 v[88:103], a[4:7], a[64:67], v[88:103]
    s_waitcnt vmcnt(10)
    ds_read_b64_tr_b16 a[8:9], v14 offset:2048
    ds_read_b64_tr_b16 a[10:11], v14 offset:2560
    ds_read_b64_tr_b16 a[12:13], v15 offset:2048
    ds_read_b64_tr_b16 a[14:15], v15 offset:2560
    v_mfma_f32_32x32x16_bf16 v[72:87], a[0:3], a[68:71], v[72:87]
    s_add_u32 m0, s57, 14336
    s_add_u32 s58, s45, 286720
    buffer_load_dwordx4 v10, s[12:15], s58 offen lds
    buffer_load_dwordx4 v11, s[12:15], s58 offen offset:1024 lds
    v_mfma_f32_32x32x16_bf16 v[104:119], a[4:7], a[68:71], v[104:119]
    v_mfma_f32_16x16x32_bf16 v[120:123], a[0:3], a[72:75], v[120:123]
    v_mfma_f32_16x16x32_bf16 v[124:127], a[4:7], a[72:75], v[124:127]
    s_waitcnt lgkmcnt(2)
    v_mfma_f32_32x32x16_bf16 v[56:71], a[8:11], a[76:79], v[56:71]
    ds_read_b128 a[64:67], v24 offset:17408
    ds_read_b128 a[68:71], v24 offset:21504
    ds_read_b128 a[72:75], v36 offset:17408
    s_waitcnt lgkmcnt(3)
    v_mfma_f32_32x32x16_bf16 v[88:103], a[12:15], a[76:79], v[88:103]
    s_waitcnt vmcnt(10)
    ds_read_b64_tr_b16 a[16:17], v14 offset:4096
    ds_read_b64_tr_b16 a[18:19], v14 offset:4608
    ds_read_b64_tr_b16 a[20:21], v15 offset:4096
    ds_read_b64_tr_b16 a[22:23], v15 offset:4608
    v_mfma_f32_32x32x16_bf16 v[72:87], a[8:11], a[80:83], v[72:87]
    s_add_u32 m0, s57, 0
    s_add_u32 s58, s46, 0
    buffer_load_dwordx4 v10, s[12:15], s58 offen lds
    buffer_load_dwordx4 v11, s[12:15], s58 offen offset:1024 lds
    v_mfma_f32_32x32x16_bf16 v[104:119], a[12:15], a[80:83], v[104:119]
    v_mfma_f32_16x16x32_bf16 v[120:123], a[8:11], a[84:87], v[120:123]
    v_mfma_f32_16x16x32_bf16 v[124:127], a[12:15], a[84:87], v[124:127]
    s_waitcnt lgkmcnt(2)
    v_mfma_f32_32x32x16_bf16 v[56:71], a[16:19], a[64:67], v[56:71]
    ds_read_b128 a[76:79], v25 offset:17408
    ds_read_b128 a[80:83], v25 offset:21504
    ds_read_b128 a[84:87], v37 offset:17408
    s_waitcnt lgkmcnt(3)
    v_mfma_f32_32x32x16_bf16 v[88:103], a[20:23], a[64:67], v[88:103]
    s_waitcnt vmcnt(10)
    ds_read_b64_tr_b16 a[24:25], v14 offset:6144
    ds_read_b64_tr_b16 a[26:27], v14 offset:6656
    ds_read_b64_tr_b16 a[28:29], v15 offset:6144
    ds_read_b64_tr_b16 a[30:31], v15 offset:6656
    v_mfma_f32_32x32x16_bf16 v[72:87], a[16:19], a[68:71], v[72:87]
    s_add_u32 m0, s57, 2048
    s_add_u32 s58, s46, 8192
    buffer_load_dwordx4 v10, s[12:15], s58 offen lds
    buffer_load_dwordx4 v11, s[12:15], s58 offen offset:1024 lds
    v_mfma_f32_32x32x16_bf16 v[104:119], a[20:23], a[68:71], v[104:119]
    v_mfma_f32_16x16x32_bf16 v[120:123], a[16:19], a[72:75], v[120:123]
    v_mfma_f32_16x16x32_bf16 v[124:127], a[20:23], a[72:75], v[124:127]
    s_waitcnt lgkmcnt(2)
    v_mfma_f32_32x32x16_bf16 v[56:71], a[24:27], a[76:79], v[56:71]
    ds_read_b128 a[64:67], v26 offset:17408
    ds_read_b128 a[68:71], v26 offset:21504
    ds_read_b128 a[72:75], v38 offset:17408
    s_waitcnt lgkmcnt(3)
    v_mfma_f32_32x32x16_bf16 v[88:103], a[28:31], a[76:79], v[88:103]
    s_waitcnt vmcnt(10)
    ds_read_b64_tr_b16 a[32:33], v14 offset:8192
    ds_read_b64_tr_b16 a[34:35], v14 offset:8704
    ds_read_b64_tr_b16 a[36:37], v15 offset:8192
    ds_read_b64_tr_b16 a[38:39], v15 offset:8704
    v_mfma_f32_32x32x16_bf16 v[72:87], a[24:27], a[80:83], v[72:87]
    s_add_u32 m0, s57, 4096
    s_add_u32 s58, s46, 16384
    buffer_load_dwordx4 v10, s[12:15], s58 offen lds
    buffer_load_dwordx4 v11, s[12:15], s58 offen offset:1024 lds
    v_mfma_f32_32x32x16_bf16 v[104:119], a[28:31], a[80:83], v[104:119]
    v_mfma_f32_16x16x32_bf16 v[120:123], a[24:27], a[84:87], v[120:123]
    v_mfma_f32_16x16x32_bf16 v[124:127], a[28:31], a[84:87], v[124:127]
    s_waitcnt lgkmcnt(2)
    v_mfma_f32_32x32x16_bf16 v[56:71], a[32:35], a[64:67], v[56:71]
    ds_read_b128 a[76:79], v27 offset:17408
    ds_read_b128 a[80:83], v27 offset:21504
    ds_read_b128 a[84:87], v39 offset:17408
    s_waitcnt lgkmcnt(3)
    v_mfma_f32_32x32x16_bf16 v[88:103], a[36:39], a[64:67], v[88:103]
    s_waitcnt vmcnt(10)
    ds_read_b64_tr_b16 a[40:41], v14 offset:10240
    ds_read_b64_tr_b16 a[42:43], v14 offset:10752
    ds_read_b64_tr_b16 a[44:45], v15 offset:10240
    ds_read_b64_tr_b16 a[46:47], v15 offset:10752
    v_mfma_f32_32x32x16_bf16 v[72:87], a[32:35], a[68:71], v[72:87]
    s_add_u32 m0, s57, 6144
    s_add_u32 s58, s46, 24576
    buffer_load_dwordx4 v10, s[12:15], s58 offen lds
    buffer_load_dwordx4 v11, s[12:15], s58 offen offset:1024 lds
    v_mfma_f32_32x32x16_bf16 v[104:119], a[36:39], a[68:71], v[104:119]
    v_mfma_f32_16x16x32_bf16 v[120:123], a[32:35], a[72:75], v[120:123]
    v_mfma_f32_16x16x32_bf16 v[124:127], a[36:39], a[72:75], v[124:127]
    s_waitcnt lgkmcnt(2)
    v_mfma_f32_32x32x16_bf16 v[56:71], a[40:43], a[76:79], v[56:71]
    ds_read_b128 a[64:67], v28 offset:17408
    ds_read_b128 a[68:71], v28 offset:21504
    ds_read_b128 a[72:75], v40 offset:17408
    s_waitcnt lgkmcnt(3)
    v_mfma_f32_32x32x16_bf16 v[88:103], a[44:47], a[76:79], v[88:103]
    s_waitcnt vmcnt(10)
    ds_read_b64_tr_b16 a[48:49], v14 offset:12288
    ds_read_b64_tr_b16 a[50:51], v14 offset:12800
    ds_read_b64_tr_b16 a[52:53], v15 offset:12288
    ds_read_b64_tr_b16 a[54:55], v15 offset:12800
    v_mfma_f32_32x32x16_bf16 v[72:87], a[40:43], a[80:83], v[72:87]
    s_add_u32 m0, s57, 8192
    s_add_u32 s58, s46, 131072
    buffer_load_dwordx4 v10, s[12:15], s58 offen lds
    buffer_load_dwordx4 v11, s[12:15], s58 offen offset:1024 lds
    v_mfma_f32_32x32x16_bf16 v[104:119], a[44:47], a[80:83], v[104:119]
    v_mfma_f32_16x16x32_bf16 v[120:123], a[40:43], a[84:87], v[120:123]
    v_mfma_f32_16x16x32_bf16 v[124:127], a[44:47], a[84:87], v[124:127]
    s_waitcnt lgkmcnt(2)
    v_mfma_f32_32x32x16_bf16 v[56:71], a[48:51], a[64:67], v[56:71]
    ds_read_b128 a[76:79], v29 offset:17408
    ds_read_b128 a[80:83], v29 offset:21504
    ds_read_b128 a[84:87], v41 offset:17408
    s_waitcnt lgkmcnt(3)
    v_mfma_f32_32x32x16_bf16 v[88:103], a[52:55], a[64:67], v[88:103]
    s_waitcnt vmcnt(10)
    ds_read_b64_tr_b16 a[56:57], v14 offset:14336
    ds_read_b64_tr_b16 a[58:59], v14 offset:14848
    ds_read_b64_tr_b16 a[60:61], v15 offset:14336
    ds_read_b64_tr_b16 a[62:63], v15 offset:14848
    v_mfma_f32_32x32x16_bf16 v[72:87], a[48:51], a[68:71], v[72:87]
    s_add_u32 m0, s57, 10240
    s_add_u32 s58, s46, 139264
    buffer_load_dwordx4 v10, s[12:15], s58 offen lds
    buffer_load_dwordx4 v11, s[12:15], s58 offen offset:1024 lds
    v_mfma_f32_32x32x16_bf16 v[104:119], a[52:55], a[68:71], v[104:119]
    v_mfma_f32_16x16x32_bf16 v[120:123], a[48:51], a[72:75], v[120:123]
    v_mfma_f32_16x16x32_bf16 v[124:127], a[52:55], a[72:75], v[124:127]
    s_waitcnt lgkmcnt(2)
    v_mfma_f32_32x32x16_bf16 v[56:71], a[56:59], a[76:79], v[56:71]
    ds_read_b128 a[64:67], v18 offset:34816
    ds_read_b128 a[68:71], v18 offset:38912
    ds_read_b128 a[72:75], v30 offset:34816
    s_waitcnt lgkmcnt(3)
    v_mfma_f32_32x32x16_bf16 v[88:103], a[60:63], a[76:79], v[88:103]
    s_waitcnt vmcnt(10)
    ds_read_b64_tr_b16 a[0:1], v14
    ds_read_b64_tr_b16 a[2:3], v14 offset:512
    ds_read_b64_tr_b16 a[4:5], v15
    ds_read_b64_tr_b16 a[6:7], v15 offset:512
    v_mfma_f32_32x32x16_bf16 v[72:87], a[56:59], a[80:83], v[72:87]
    s_add_u32 m0, s57, 12288
    s_add_u32 s58, s46, 147456
    buffer_load_dwordx4 v10, s[12:15], s58 offen lds
    buffer_load_dwordx4 v11, s[12:15], s58 offen offset:1024 lds
    v_mfma_f32_32x32x16_bf16 v[104:119], a[60:63], a[80:83], v[104:119]
    v_mfma_f32_16x16x32_bf16 v[120:123], a[56:59], a[84:87], v[120:123]
    v_mfma_f32_16x16x32_bf16 v[124:127], a[60:63], a[84:87], v[124:127]
    s_waitcnt lgkmcnt(2)
    v_mfma_f32_32x32x16_bf16 v[56:71], a[0:3], a[64:67], v[56:71]
    ds_read_b128 a[76:79], v19 offset:34816
    ds_read_b128 a[80:83], v19 offset:38912
    ds_read_b128 a[84:87], v31 offset:34816
    s_waitcnt lgkmcnt(3)
    v_mfma_f32_32x32x16_bf16 v[88:103], a[4:7], a[64:67], v[88:103]
    s_waitcnt vmcnt(10)
    ds_read_b64_tr_b16 a[8:9], v14 offset:2048
    ds_read_b64_tr_b16 a[10:11], v14 offset:2560
    ds_read_b64_tr_b16 a[12:13], v15 offset:2048
    ds_read_b64_tr_b16 a[14:15], v15 offset:2560
    v_mfma_f32_32x32x16_bf16 v[72:87], a[0:3], a[68:71], v[72:87]
    s_add_u32 m0, s57, 14336
    s_add_u32 s58, s46, 155648
    buffer_load_dwordx4 v10, s[12:15], s58 offen lds
    buffer_load_dwordx4 v11, s[12:15], s58 offen offset:1024 lds
    v_mfma_f32_32x32x16_bf16 v[104:119], a[4:7], a[68:71], v[104:119]
    v_mfma_f32_16x16x32_bf16 v[120:123], a[0:3], a[72:75], v[120:123]
    v_mfma_f32_16x16x32_bf16 v[124:127], a[4:7], a[72:75], v[124:127]
    s_waitcnt lgkmcnt(2)
    v_mfma_f32_32x32x16_bf16 v[56:71], a[8:11], a[76:79], v[56:71]
    ds_read_b128 a[64:67], v20 offset:34816
    ds_read_b128 a[68:71], v20 offset:38912
    ds_read_b128 a[72:75], v32 offset:34816
    s_waitcnt lgkmcnt(3)
    v_mfma_f32_32x32x16_bf16 v[88:103], a[12:15], a[76:79], v[88:103]
    s_waitcnt vmcnt(10)
    ds_read_b64_tr_b16 a[16:17], v14 offset:4096
    ds_read_b64_tr_b16 a[18:19], v14 offset:4608
    ds_read_b64_tr_b16 a[20:21], v15 offset:4096
    ds_read_b64_tr_b16 a[22:23], v15 offset:4608
    v_mfma_f32_32x32x16_bf16 v[72:87], a[8:11], a[80:83], v[72:87]
    s_add_u32 m0, s57, 0
    s_add_u32 s58, s46, 262144
    buffer_load_dwordx4 v10, s[12:15], s58 offen lds
    buffer_load_dwordx4 v11, s[12:15], s58 offen offset:1024 lds
    v_mfma_f32_32x32x16_bf16 v[104:119], a[12:15], a[80:83], v[104:119]
    v_mfma_f32_16x16x32_bf16 v[120:123], a[8:11], a[84:87], v[120:123]
    v_mfma_f32_16x16x32_bf16 v[124:127], a[12:15], a[84:87], v[124:127]
    s_waitcnt lgkmcnt(2)
    v_mfma_f32_32x32x16_bf16 v[56:71], a[16:19], a[64:67], v[56:71]
    ds_read_b128 a[76:79], v21 offset:34816
    ds_read_b128 a[80:83], v21 offset:38912
    ds_read_b128 a[84:87], v33 offset:34816
    s_waitcnt lgkmcnt(3)
    v_mfma_f32_32x32x16_bf16 v[88:103], a[20:23], a[64:67], v[88:103]
    s_waitcnt vmcnt(10)
    ds_read_b64_tr_b16 a[24:25], v14 offset:6144
    ds_read_b64_tr_b16 a[26:27], v14 offset:6656
    ds_read_b64_tr_b16 a[28:29], v15 offset:6144
    ds_read_b64_tr_b16 a[30:31], v15 offset:6656
    v_mfma_f32_32x32x16_bf16 v[72:87], a[16:19], a[68:71], v[72:87]
    s_add_u32 m0, s57, 2048
    s_add_u32 s58, s46, 270336
    buffer_load_dwordx4 v10, s[12:15], s58 offen lds
    buffer_load_dwordx4 v11, s[12:15], s58 offen offset:1024 lds
    v_mfma_f32_32x32x16_bf16 v[104:119], a[20:23], a[68:71], v[104:119]
    v_mfma_f32_16x16x32_bf16 v[120:123], a[16:19], a[72:75], v[120:123]
    v_mfma_f32_16x16x32_bf16 v[124:127], a[20:23], a[72:75], v[124:127]
    s_waitcnt lgkmcnt(2)
    v_mfma_f32_32x32x16_bf16 v[56:71], a[24:27], a[76:79], v[56:71]
    ds_read_b128 a[64:67], v22 offset:34816
    ds_read_b128 a[68:71], v22 offset:38912
    ds_read_b128 a[72:75], v34 offset:34816
    s_waitcnt lgkmcnt(3)
    v_mfma_f32_32x32x16_bf16 v[88:103], a[28:31], a[76:79], v[88:103]
    s_waitcnt vmcnt(10)
    ds_read_b64_tr_b16 a[32:33], v14 offset:8192
    ds_read_b64_tr_b16 a[34:35], v14 offset:8704
    ds_read_b64_tr_b16 a[36:37], v15 offset:8192
    ds_read_b64_tr_b16 a[38:39], v15 offset:8704
    v_mfma_f32_32x32x16_bf16 v[72:87], a[24:27], a[80:83], v[72:87]
    s_add_u32 m0, s57, 4096
    s_add_u32 s58, s46, 278528
    buffer_load_dwordx4 v10, s[12:15], s58 offen lds
    buffer_load_dwordx4 v11, s[12:15], s58 offen offset:1024 lds
    v_mfma_f32_32x32x16_bf16 v[104:119], a[28:31], a[80:83], v[104:119]
    v_mfma_f32_16x16x32_bf16 v[120:123], a[24:27], a[84:87], v[120:123]
    v_mfma_f32_16x16x32_bf16 v[124:127], a[28:31], a[84:87], v[124:127]
    s_waitcnt lgkmcnt(2)
    v_mfma_f32_32x32x16_bf16 v[56:71], a[32:35], a[64:67], v[56:71]
    ds_read_b128 a[76:79], v23 offset:34816
    ds_read_b128 a[80:83], v23 offset:38912
    ds_read_b128 a[84:87], v35 offset:34816
    s_waitcnt lgkmcnt(3)
    v_mfma_f32_32x32x16_bf16 v[88:103], a[36:39], a[64:67], v[88:103]
    s_waitcnt vmcnt(10)
    ds_read_b64_tr_b16 a[40:41], v14 offset:10240
    ds_read_b64_tr_b16 a[42:43], v14 offset:10752
    ds_read_b64_tr_b16 a[44:45], v15 offset:10240
    ds_read_b64_tr_b16 a[46:47], v15 offset:10752
    v_mfma_f32_32x32x16_bf16 v[72:87], a[32:35], a[68:71], v[72:87]
    s_add_u32 m0, s57, 6144
    s_add_u32 s58, s46, 286720
    buffer_load_dwordx4 v10, s[12:15], s58 offen lds
    buffer_load_dwordx4 v11, s[12:15], s58 offen offset:1024 lds
    v_mfma_f32_32x32x16_bf16 v[104:119], a[36:39], a[68:71], v[104:119]
    v_mfma_f32_16x16x32_bf16 v[120:123], a[32:35], a[72:75], v[120:123]
    v_mfma_f32_16x16x32_bf16 v[124:127], a[36:39], a[72:75], v[124:127]
    s_waitcnt lgkmcnt(2)
    v_mfma_f32_32x32x16_bf16 v[56:71], a[40:43], a[76:79], v[56:71]
    ds_read_b128 a[64:67], v24 offset:34816
    ds_read_b128 a[68:71], v24 offset:38912
    ds_read_b128 a[72:75], v36 offset:34816
    s_waitcnt lgkmcnt(3)
    v_mfma_f32_32x32x16_bf16 v[88:103], a[44:47], a[76:79], v[88:103]
    s_waitcnt vmcnt(10)
    ds_read_b64_tr_b16 a[48:49], v14 offset:12288
    ds_read_b64_tr_b16 a[50:51], v14 offset:12800
    ds_read_b64_tr_b16 a[52:53], v15 offset:12288
    ds_read_b64_tr_b16 a[54:55], v15 offset:12800
    v_mfma_f32_32x32x16_bf16 v[72:87], a[40:43], a[80:83], v[72:87]
    s_add_u32 m0, s57, 8192
    s_add_u32 s58, s47, 0
    buffer_load_dwordx4 v10, s[12:15], s58 offen lds
    buffer_load_dwordx4 v11, s[12:15], s58 offen offset:1024 lds
    v_mfma_f32_32x32x16_bf16 v[104:119], a[44:47], a[80:83], v[104:119]
    v_mfma_f32_16x16x32_bf16 v[120:123], a[40:43], a[84:87], v[120:123]
    v_mfma_f32_16x16x32_bf16 v[124:127], a[44:47], a[84:87], v[124:127]
    s_waitcnt lgkmcnt(2)
    v_mfma_f32_32x32x16_bf16 v[56:71], a[48:51], a[64:67], v[56:71]
    ds_read_b128 a[76:79], v25 offset:34816
    ds_read_b128 a[80:83], v25 offset:38912
    ds_read_b128 a[84:87], v37 offset:34816
    s_waitcnt lgkmcnt(3)
    v_mfma_f32_32x32x16_bf16 v[88:103], a[52:55], a[64:67], v[88:103]
    s_waitcnt vmcnt(10)
    ds_read_b64_tr_b16 a[56:57], v14 offset:14336
    ds_read_b64_tr_b16 a[58:59], v14 offset:14848
    ds_read_b64_tr_b16 a[60:61], v15 offset:14336
    ds_read_b64_tr_b16 a[62:63], v15 offset:14848
    v_mfma_f32_32x32x16_bf16 v[72:87], a[48:51], a[68:71], v[72:87]
    s_add_u32 m0, s57, 10240
    s_add_u32 s58, s47, 8192
    buffer_load_dwordx4 v10, s[12:15], s58 offen lds
    buffer_load_dwordx4 v11, s[12:15], s58 offen offset:1024 lds
    v_mfma_f32_32x32x16_bf16 v[104:119], a[52:55], a[68:71], v[104:119]
    v_mfma_f32_16x16x32_bf16 v[120:123], a[48:51], a[72:75], v[120:123]
    v_mfma_f32_16x16x32_bf16 v[124:127], a[52:55], a[72:75], v[124:127]
    s_waitcnt lgkmcnt(2)
    v_mfma_f32_32x32x16_bf16 v[56:71], a[56:59], a[76:79], v[56:71]
    ds_read_b128 a[64:67], v26 offset:34816
    ds_read_b128 a[68:71], v26 offset:38912
    ds_read_b128 a[72:75], v38 offset:34816
    s_waitcnt lgkmcnt(3)
    v_mfma_f32_32x32x16_bf16 v[88:103], a[60:63], a[76:79], v[88:103]
    s_waitcnt vmcnt(10)
    ds_read_b64_tr_b16 a[0:1], v14
    ds_read_b64_tr_b16 a[2:3], v14 offset:512
    ds_read_b64_tr_b16 a[4:5], v15
    ds_read_b64_tr_b16 a[6:7], v15 offset:512
    v_mfma_f32_32x32x16_bf16 v[72:87], a[56:59], a[80:83], v[72:87]
    s_add_u32 m0, s57, 12288
    s_add_u32 s58, s47, 16384
    buffer_load_dwordx4 v10, s[12:15], s58 offen lds
    buffer_load_dwordx4 v11, s[12:15], s58 offen offset:1024 lds
    v_mfma_f32_32x32x16_bf16 v[104:119], a[60:63], a[80:83], v[104:119]
    v_mfma_f32_16x16x32_bf16 v[120:123], a[56:59], a[84:87], v[120:123]
    v_mfma_f32_16x16x32_bf16 v[124:127], a[60:63], a[84:87], v[124:127]
    s_waitcnt lgkmcnt(2)
    v_mfma_f32_32x32x16_bf16 v[56:71], a[0:3], a[64:67], v[56:71]
    ds_read_b128 a[76:79], v27 offset:34816
    ds_read_b128 a[80:83], v27 offset:38912
    ds_read_b128 a[84:87], v39 offset:34816
    s_waitcnt lgkmcnt(3)
    v_mfma_f32_32x32x16_bf16 v[88:103], a[4:7], a[64:67], v[88:103]
    s_waitcnt vmcnt(10)
    ds_read_b64_tr_b16 a[8:9], v14 offset:2048
    ds_read_b64_tr_b16 a[10:11], v14 offset:2560
    ds_read_b64_tr_b16 a[12:13], v15 offset:2048
    ds_read_b64_tr_b16 a[14:15], v15 offset:2560
    v_mfma_f32_32x32x16_bf16 v[72:87], a[0:3], a[68:71], v[72:87]
    s_add_u32 m0, s57, 14336
    s_add_u32 s58, s47, 24576
    buffer_load_dwordx4 v10, s[12:15], s58 offen lds
    buffer_load_dwordx4 v11, s[12:15], s58 offen offset:1024 lds
    v_mfma_f32_32x32x16_bf16 v[104:119], a[4:7], a[68:71], v[104:119]
    v_mfma_f32_16x16x32_bf16 v[120:123], a[0:3], a[72:75], v[120:123]
    v_mfma_f32_16x16x32_bf16 v[124:127], a[4:7], a[72:75], v[124:127]
    s_waitcnt lgkmcnt(2)
    v_mfma_f32_32x32x16_bf16 v[56:71], a[8:11], a[76:79], v[56:71]
    ds_read_b128 a[64:67], v28 offset:34816
    ds_read_b128 a[68:71], v28 offset:38912
    ds_read_b128 a[72:75], v40 offset:34816
    s_waitcnt lgkmcnt(3)
    v_mfma_f32_32x32x16_bf16 v[88:103], a[12:15], a[76:79], v[88:103]
    s_waitcnt vmcnt(10)
    ds_read_b64_tr_b16 a[16:17], v14 offset:4096
    ds_read_b64_tr_b16 a[18:19], v14 offset:4608
    ds_read_b64_tr_b16 a[20:21], v15 offset:4096
    ds_read_b64_tr_b16 a[22:23], v15 offset:4608
    v_mfma_f32_32x32x16_bf16 v[72:87], a[8:11], a[80:83], v[72:87]
    s_add_u32 m0, s57, 0
    s_add_u32 s58, s47, 131072
    buffer_load_dwordx4 v10, s[12:15], s58 offen lds
    buffer_load_dwordx4 v11, s[12:15], s58 offen offset:1024 lds
    v_mfma_f32_32x32x16_bf16 v[104:119], a[12:15], a[80:83], v[104:119]
    v_mfma_f32_16x16x32_bf16 v[120:123], a[8:11], a[84:87], v[120:123]
    v_mfma_f32_16x16x32_bf16 v[124:127], a[12:15], a[84:87], v[124:127]
    s_waitcnt lgkmcnt(2)
    v_mfma_f32_32x32x16_bf16 v[56:71], a[16:19], a[64:67], v[56:71]
    ds_read_b128 a[76:79], v29 offset:34816
    ds_read_b128 a[80:83], v29 offset:38912
    ds_read_b128 a[84:87], v41 offset:34816
    s_waitcnt lgkmcnt(3)
    v_mfma_f32_32x32x16_bf16 v[88:103], a[20:23], a[64:67], v[88:103]
    s_waitcnt vmcnt(10)
    ds_read_b64_tr_b16 a[24:25], v14 offset:6144
    ds_read_b64_tr_b16 a[26:27], v14 offset:6656
    ds_read_b64_tr_b16 a[28:29], v15 offset:6144
    ds_read_b64_tr_b16 a[30:31], v15 offset:6656
    v_mfma_f32_32x32x16_bf16 v[72:87], a[16:19], a[68:71], v[72:87]
    s_add_u32 m0, s57, 2048
    s_add_u32 s58, s47, 139264
    buffer_load_dwordx4 v10, s[12:15], s58 offen lds
    buffer_load_dwordx4 v11, s[12:15], s58 offen offset:1024 lds
    v_mfma_f32_32x32x16_bf16 v[104:119], a[20:23], a[68:71], v[104:119]
    v_mfma_f32_16x16x32_bf16 v[120:123], a[16:19], a[72:75], v[120:123]
    v_mfma_f32_16x16x32_bf16 v[124:127], a[20:23], a[72:75], v[124:127]
    s_waitcnt lgkmcnt(2)
    v_mfma_f32_32x32x16_bf16 v[56:71], a[24:27], a[76:79], v[56:71]
    ds_read_b128 a[64:67], v18 offset:52224
    ds_read_b128 a[68:71], v18 offset:56320
    ds_read_b128 a[72:75], v30 offset:52224
    s_waitcnt lgkmcnt(3)
    v_mfma_f32_32x32x16_bf16 v[88:103], a[28:31], a[76:79], v[88:103]
    s_waitcnt vmcnt(10)
    ds_read_b64_tr_b16 a[32:33], v14 offset:8192
    ds_read_b64_tr_b16 a[34:35], v14 offset:8704
    ds_read_b64_tr_b16 a[36:37], v15 offset:8192
    ds_read_b64_tr_b16 a[38:39], v15 offset:8704
    v_mfma_f32_32x32x16_bf16 v[72:87], a[24:27], a[80:83], v[72:87]
    s_add_u32 m0, s57, 4096
    s_add_u32 s58, s47, 147456
    buffer_load_dwordx4 v10, s[12:15], s58 offen lds
    buffer_load_dwordx4 v11, s[12:15], s58 offen offset:1024 lds
    v_mfma_f32_32x32x16_bf16 v[104:119], a[28:31], a[80:83], v[104:119]
    v_mfma_f32_16x16x32_bf16 v[120:123], a[24:27], a[84:87], v[120:123]
    v_mfma_f32_16x16x32_bf16 v[124:127], a[28:31], a[84:87], v[124:127]
    s_waitcnt lgkmcnt(2)
    v_mfma_f32_32x32x16_bf16 v[56:71], a[32:35], a[64:67], v[56:71]
    ds_read_b128 a[76:79], v19 offset:52224
    ds_read_b128 a[80:83], v19 offset:56320
    ds_read_b128 a[84:87], v31 offset:52224
    s_waitcnt lgkmcnt(3)
    v_mfma_f32_32x32x16_bf16 v[88:103], a[36:39], a[64:67], v[88:103]
    s_waitcnt vmcnt(10)
    ds_read_b64_tr_b16 a[40:41], v14 offset:10240
    ds_read_b64_tr_b16 a[42:43], v14 offset:10752
    ds_read_b64_tr_b16 a[44:45], v15 offset:10240
    ds_read_b64_tr_b16 a[46:47], v15 offset:10752
    v_mfma_f32_32x32x16_bf16 v[72:87], a[32:35], a[68:71], v[72:87]
    s_add_u32 m0, s57, 6144
    s_add_u32 s58, s47, 155648
    buffer_load_dwordx4 v10, s[12:15], s58 offen lds
    buffer_load_dwordx4 v11, s[12:15], s58 offen offset:1024 lds
    v_mfma_f32_32x32x16_bf16 v[104:119], a[36:39], a[68:71], v[104:119]
    v_mfma_f32_16x16x32_bf16 v[120:123], a[32:35], a[72:75], v[120:123]
    v_mfma_f32_16x16x32_bf16 v[124:127], a[36:39], a[72:75], v[124:127]
    s_waitcnt lgkmcnt(2)
    v_mfma_f32_32x32x16_bf16 v[56:71], a[40:43], a[76:79], v[56:71]
    ds_read_b128 a[64:67], v20 offset:52224
    ds_read_b128 a[68:71], v20 offset:56320
    ds_read_b128 a[72:75], v32 offset:52224
    s_waitcnt lgkmcnt(3)
    v_mfma_f32_32x32x16_bf16 v[88:103], a[44:47], a[76:79], v[88:103]
    s_waitcnt vmcnt(10)
    ds_read_b64_tr_b16 a[48:49], v14 offset:12288
    ds_read_b64_tr_b16 a[50:51], v14 offset:12800
    ds_read_b64_tr_b16 a[52:53], v15 offset:12288
    ds_read_b64_tr_b16 a[54:55], v15 offset:12800
    v_mfma_f32_32x32x16_bf16 v[72:87], a[40:43], a[80:83], v[72:87]
    s_add_u32 m0, s57, 8192
    s_add_u32 s58, s47, 262144
    buffer_load_dwordx4 v10, s[12:15], s58 offen lds
    buffer_load_dwordx4 v11, s[12:15], s58 offen offset:1024 lds
    v_mfma_f32_32x32x16_bf16 v[104:119], a[44:47], a[80:83], v[104:119]
    v_mfma_f32_16x16x32_bf16 v[120:123], a[40:43], a[84:87], v[120:123]
    v_mfma_f32_16x16x32_bf16 v[124:127], a[44:47], a[84:87], v[124:127]
    s_waitcnt lgkmcnt(2)
    v_mfma_f32_32x32x16_bf16 v[56:71], a[48:51], a[64:67], v[56:71]
    ds_read_b128 a[76:79], v21 offset:52224
    ds_read_b128 a[80:83], v21 offset:56320
    ds_read_b128 a[84:87], v33 offset:52224
    s_waitcnt lgkmcnt(3)
    v_mfma_f32_32x32x16_bf16 v[88:103], a[52:55], a[64:67], v[88:103]
    s_waitcnt vmcnt(10)
    ds_read_b64_tr_b16 a[56:57], v14 offset:14336
    ds_read_b64_tr_b16 a[58:59], v14 offset:14848
    ds_read_b64_tr_b16 a[60:61], v15 offset:14336
    ds_read_b64_tr_b16 a[62:63], v15 offset:14848
    v_mfma_f32_32x32x16_bf16 v[72:87], a[48:51], a[68:71], v[72:87]
    s_add_u32 m0, s57, 10240
    s_add_u32 s58, s47, 270336
    buffer_load_dwordx4 v10, s[12:15], s58 offen lds
    buffer_load_dwordx4 v11, s[12:15], s58 offen offset:1024 lds
    v_mfma_f32_32x32x16_bf16 v[104:119], a[52:55], a[68:71], v[104:119]
    v_mfma_f32_16x16x32_bf16 v[120:123], a[48:51], a[72:75], v[120:123]
    v_mfma_f32_16x16x32_bf16 v[124:127], a[52:55], a[72:75], v[124:127]
    s_waitcnt lgkmcnt(2)
    v_mfma_f32_32x32x16_bf16 v[56:71], a[56:59], a[76:79], v[56:71]
    ds_read_b128 a[64:67], v22 offset:52224
    ds_read_b128 a[68:71], v22 offset:56320
    ds_read_b128 a[72:75], v34 offset:52224
    s_waitcnt lgkmcnt(3)
    v_mfma_f32_32x32x16_bf16 v[88:103], a[60:63], a[76:79], v[88:103]
    s_waitcnt vmcnt(10)
    ds_read_b64_tr_b16 a[0:1], v14
    ds_read_b64_tr_b16 a[2:3], v14 offset:512
    ds_read_b64_tr_b16 a[4:5], v15
    ds_read_b64_tr_b16 a[6:7], v15 offset:512
    v_mfma_f32_32x32x16_bf16 v[72:87], a[56:59], a[80:83], v[72:87]
    s_add_u32 m0, s57, 12288
    s_add_u32 s58, s47, 278528
    buffer_load_dwordx4 v10, s[12:15], s58 offen lds
    buffer_load_dwordx4 v11, s[12:15], s58 offen offset:1024 lds
    v_mfma_f32_32x32x16_bf16 v[104:119], a[60:63], a[80:83], v[104:119]
    v_mfma_f32_16x16x32_bf16 v[120:123], a[56:59], a[84:87], v[120:123]
    v_mfma_f32_16x16x32_bf16 v[124:127], a[60:63], a[84:87], v[124:127]
    s_waitcnt lgkmcnt(2)
    v_mfma_f32_32x32x16_bf16 v[56:71], a[0:3], a[64:67], v[56:71]
    ds_read_b128 a[76:79], v23 offset:52224
    ds_read_b128 a[80:83], v23 offset:56320
    ds_read_b128 a[84:87], v35 offset:52224
    s_waitcnt lgkmcnt(3)
    v_mfma_f32_32x32x16_bf16 v[88:103], a[4:7], a[64:67], v[88:103]
    s_waitcnt vmcnt(10)
    ds_read_b64_tr_b16 a[8:9], v14 offset:2048
    ds_read_b64_tr_b16 a[10:11], v14 offset:2560
    ds_read_b64_tr_b16 a[12:13], v15 offset:2048
    ds_read_b64_tr_b16 a[14:15], v15 offset:2560
    v_mfma_f32_32x32x16_bf16 v[72:87], a[0:3], a[68:71], v[72:87]
    s_add_u32 m0, s57, 14336
    s_add_u32 s58, s47, 286720
    buffer_load_dwordx4 v10, s[12:15], s58 offen lds
    buffer_load_dwordx4 v11, s[12:15], s58 offen offset:1024 lds
    v_mfma_f32_32x32x16_bf16 v[104:119], a[4:7], a[68:71], v[104:119]
    v_mfma_f32_16x16x32_bf16 v[120:123], a[0:3], a[72:75], v[120:123]
    v_mfma_f32_16x16x32_bf16 v[124:127], a[4:7], a[72:75], v[124:127]
    s_waitcnt lgkmcnt(2)
    v_mfma_f32_32x32x16_bf16 v[56:71], a[8:11], a[76:79], v[56:71]
    ds_read_b128 a[64:67], v24 offset:52224
    ds_read_b128 a[68:71], v24 offset:56320
    ds_read_b128 a[72:75], v36 offset:52224
    s_waitcnt lgkmcnt(3)
    v_mfma_f32_32x32x16_bf16 v[88:103], a[12:15], a[76:79], v[88:103]
    s_waitcnt vmcnt(10)
    ds_read_b64_tr_b16 a[16:17], v14 offset:4096
    ds_read_b64_tr_b16 a[18:19], v14 offset:4608
    ds_read_b64_tr_b16 a[20:21], v15 offset:4096
    ds_read_b64_tr_b16 a[22:23], v15 offset:4608
    v_mfma_f32_32x32x16_bf16 v[72:87], a[8:11], a[80:83], v[72:87]
    s_add_u32 m0, s57, 0
    s_mov_b32 s58, 0
    buffer_load_dwordx4 v10, s[16:19], s58 offen lds
    buffer_load_dwordx4 v11, s[16:19], s58 offen offset:1024 lds
    v_mfma_f32_32x32x16_bf16 v[104:119], a[12:15], a[80:83], v[104:119]
    v_mfma_f32_16x16x32_bf16 v[120:123], a[8:11], a[84:87], v[120:123]
    v_mfma_f32_16x16x32_bf16 v[124:127], a[12:15], a[84:87], v[124:127]
    s_waitcnt lgkmcnt(2)
    v_mfma_f32_32x32x16_bf16 v[56:71], a[16:19], a[64:67], v[56:71]
    ds_read_b128 a[76:79], v25 offset:52224
    ds_read_b128 a[80:83], v25 offset:56320
    ds_read_b128 a[84:87], v37 offset:52224
    s_waitcnt lgkmcnt(3)
    v_mfma_f32_32x32x16_bf16 v[88:103], a[20:23], a[64:67], v[88:103]
    s_waitcnt vmcnt(10)
    ds_read_b64_tr_b16 a[24:25], v14 offset:6144
    ds_read_b64_tr_b16 a[26:27], v14 offset:6656
    ds_read_b64_tr_b16 a[28:29], v15 offset:6144
    ds_read_b64_tr_b16 a[30:31], v15 offset:6656
    v_mfma_f32_32x32x16_bf16 v[72:87], a[16:19], a[68:71], v[72:87]
    s_add_u32 m0, s57, 2048
    s_mov_b32 s58, 8192
    buffer_load_dwordx4 v10, s[16:19], s58 offen lds
    buffer_load_dwordx4 v11, s[16:19], s58 offen offset:1024 lds
    v_mfma_f32_32x32x16_bf16 v[104:119], a[20:23], a[68:71], v[104:119]
    v_mfma_f32_16x16x32_bf16 v[120:123], a[16:19], a[72:75], v[120:123]
    v_mfma_f32_16x16x32_bf16 v[124:127], a[20:23], a[72:75], v[124:127]
    s_waitcnt lgkmcnt(2)
    v_mfma_f32_32x32x16_bf16 v[56:71], a[24:27], a[76:79], v[56:71]
    ds_read_b128 a[64:67], v26 offset:52224
    ds_read_b128 a[68:71], v26 offset:56320
    ds_read_b128 a[72:75], v38 offset:52224
    s_waitcnt lgkmcnt(3)
    v_mfma_f32_32x32x16_bf16 v[88:103], a[28:31], a[76:79], v[88:103]
    s_waitcnt vmcnt(10)
    ds_read_b64_tr_b16 a[32:33], v14 offset:8192
    ds_read_b64_tr_b16 a[34:35], v14 offset:8704
    ds_read_b64_tr_b16 a[36:37], v15 offset:8192
    ds_read_b64_tr_b16 a[38:39], v15 offset:8704
    v_mfma_f32_32x32x16_bf16 v[72:87], a[24:27], a[80:83], v[72:87]
    s_add_u32 m0, s57, 4096
    s_mov_b32 s58, 32768
    buffer_load_dwordx4 v10, s[16:19], s58 offen lds
    buffer_load_dwordx4 v11, s[16:19], s58 offen offset:1024 lds
    v_mfma_f32_32x32x16_bf16 v[104:119], a[28:31], a[80:83], v[104:119]
    v_mfma_f32_16x16x32_bf16 v[120:123], a[24:27], a[84:87], v[120:123]
    v_mfma_f32_16x16x32_bf16 v[124:127], a[28:31], a[84:87], v[124:127]
    s_waitcnt lgkmcnt(2)
    v_mfma_f32_32x32x16_bf16 v[56:71], a[32:35], a[64:67], v[56:71]
    ds_read_b128 a[76:79], v27 offset:52224
    ds_read_b128 a[80:83], v27 offset:56320
    ds_read_b128 a[84:87], v39 offset:52224
    s_waitcnt lgkmcnt(3)
    v_mfma_f32_32x32x16_bf16 v[88:103], a[36:39], a[64:67], v[88:103]
    s_waitcnt vmcnt(10)
    ds_read_b64_tr_b16 a[40:41], v14 offset:10240
    ds_read_b64_tr_b16 a[42:43], v14 offset:10752
    ds_read_b64_tr_b16 a[44:45], v15 offset:10240
    ds_read_b64_tr_b16 a[46:47], v15 offset:10752
    v_mfma_f32_32x32x16_bf16 v[72:87], a[32:35], a[68:71], v[72:87]
    s_add_u32 m0, s57, 6144
    s_mov_b32 s58, 40960
    buffer_load_dwordx4 v10, s[16:19], s58 offen lds
    buffer_load_dwordx4 v11, s[16:19], s58 offen offset:1024 lds
    v_mfma_f32_32x32x16_bf16 v[104:119], a[36:39], a[68:71], v[104:119]
    v_mfma_f32_16x16x32_bf16 v[120:123], a[32:35], a[72:75], v[120:123]
    v_mfma_f32_16x16x32_bf16 v[124:127], a[36:39], a[72:75], v[124:127]
    s_waitcnt lgkmcnt(2)
    v_mfma_f32_32x32x16_bf16 v[56:71], a[40:43], a[76:79], v[56:71]
    ds_read_b128 a[64:67], v28 offset:52224
    ds_read_b128 a[68:71], v28 offset:56320
    ds_read_b128 a[72:75], v40 offset:52224
    s_waitcnt lgkmcnt(3)
    v_mfma_f32_32x32x16_bf16 v[88:103], a[44:47], a[76:79], v[88:103]
    s_waitcnt vmcnt(10)
    ds_read_b64_tr_b16 a[48:49], v14 offset:12288
    ds_read_b64_tr_b16 a[50:51], v14 offset:12800
    ds_read_b64_tr_b16 a[52:53], v15 offset:12288
    ds_read_b64_tr_b16 a[54:55], v15 offset:12800
    v_mfma_f32_32x32x16_bf16 v[72:87], a[40:43], a[80:83], v[72:87]
    s_add_u32 m0, s57, 8192
    s_mov_b32 s58, 65536
    buffer_load_dwordx4 v10, s[16:19], s58 offen lds
    buffer_load_dwordx4 v11, s[16:19], s58 offen offset:1024 lds
    v_mfma_f32_32x32x16_bf16 v[104:119], a[44:47], a[80:83], v[104:119]
    v_mfma_f32_16x16x32_bf16 v[120:123], a[40:43], a[84:87], v[120:123]
    v_mfma_f32_16x16x32_bf16 v[124:127], a[44:47], a[84:87], v[124:127]
    s_waitcnt lgkmcnt(2)
    v_mfma_f32_32x32x16_bf16 v[56:71], a[48:51], a[64:67], v[56:71]
    ds_read_b128 a[76:79], v29 offset:52224
    ds_read_b128 a[80:83], v29 offset:56320
    ds_read_b128 a[84:87], v41 offset:52224
    s_waitcnt lgkmcnt(3)
    v_mfma_f32_32x32x16_bf16 v[88:103], a[52:55], a[64:67], v[88:103]
    s_waitcnt vmcnt(10)
    ds_read_b64_tr_b16 a[56:57], v14 offset:14336
    ds_read_b64_tr_b16 a[58:59], v14 offset:14848
    ds_read_b64_tr_b16 a[60:61], v15 offset:14336
    ds_read_b64_tr_b16 a[62:63], v15 offset:14848
    v_mfma_f32_32x32x16_bf16 v[72:87], a[48:51], a[68:71], v[72:87]
    s_add_u32 m0, s57, 10240
    s_mov_b32 s58, 73728
    buffer_load_dwordx4 v10, s[16:19], s58 offen lds
    buffer_load_dwordx4 v11, s[16:19], s58 offen offset:1024 lds
    v_mfma_f32_32x32x16_bf16 v[104:119], a[52:55], a[68:71], v[104:119]
    v_mfma_f32_16x16x32_bf16 v[120:123], a[48:51], a[72:75], v[120:123]
    v_mfma_f32_16x16x32_bf16 v[124:127], a[52:55], a[72:75], v[124:127]
    s_waitcnt lgkmcnt(2)
    v_mfma_f32_32x32x16_bf16 v[56:71], a[56:59], a[76:79], v[56:71]
    s_waitcnt lgkmcnt(0)
    v_mfma_f32_32x32x16_bf16 v[88:103], a[60:63], a[76:79], v[88:103]
    s_waitcnt vmcnt(10)
    ds_read_b64_tr_b16 a[0:1], v14
    ds_read_b64_tr_b16 a[2:3], v14 offset:512
    ds_read_b64_tr_b16 a[4:5], v15
    ds_read_b64_tr_b16 a[6:7], v15 offset:512
    v_mfma_f32_32x32x16_bf16 v[72:87], a[56:59], a[80:83], v[72:87]
    s_add_u32 m0, s57, 12288
    s_mov_b32 s58, 98304
    buffer_load_dwordx4 v10, s[16:19], s58 offen lds
    buffer_load_dwordx4 v11, s[16:19], s58 offen offset:1024 lds
    v_mfma_f32_32x32x16_bf16 v[104:119], a[60:63], a[80:83], v[104:119]
    v_mfma_f32_16x16x32_bf16 v[120:123], a[56:59], a[84:87], v[120:123]
    v_mfma_f32_16x16x32_bf16 v[124:127], a[60:63], a[84:87], v[124:127]
    s_barrier
    ds_write_b128 v53, v[88:91]
    ds_write_b128 v53, v[92:95] offset:1024
    ds_write_b128 v53, v[96:99] offset:2048
    ds_write_b128 v53, v[100:103] offset:3072
    s_nop 5
    ds_write_b128 v53, v[104:107] offset:4096
    ds_write_b128 v53, v[108:111] offset:5120
    ds_write_b128 v53, v[112:115] offset:6144
    ds_write_b128 v53, v[116:119] offset:7168
    s_waitcnt lgkmcnt(0)
    s_barrier
    v_pk_mul_f32 v[152:153], v[56:57], v[56:57]
    v_pk_mul_f32 v[154:155], v[58:59], v[58:59]
    v_pk_fma_f32 v[152:153], v[152:153], v[54:55], s[4:5]
    v_pk_fma_f32 v[154:155], v[154:155], v[54:55], s[4:5]
    v_pk_mul_f32 v[152:153], v[56:57], v[152:153]
    v_pk_mul_f32 v[154:155], v[58:59], v[154:155]
    v_exp_f32 v152, v152
    v_exp_f32 v153, v153
    v_exp_f32 v154, v154
    v_exp_f32 v155, v155
    v_pk_add_f32 v[152:153], v[152:153], 1.0 op_sel_hi:[1,0]
    v_pk_add_f32 v[154:155], v[154:155], 1.0 op_sel_hi:[1,0]
    v_rcp_f32 v152, v152
    v_rcp_f32 v153, v153
    s_waitcnt vmcnt(10)
    ds_read_b64_tr_b16 a[8:9], v14 offset:2048
    ds_read_b64_tr_b16 a[10:11], v14 offset:2560
    ds_read_b64_tr_b16 a[12:13], v15 offset:2048
    ds_read_b64_tr_b16 a[14:15], v15 offset:2560
    s_add_u32 m0, s57, 14336
    s_mov_b32 s58, 106496
    buffer_load_dwordx4 v10, s[16:19], s58 offen lds
    buffer_load_dwordx4 v11, s[16:19], s58 offen offset:1024 lds
    v_rcp_f32 v154, v154
    v_rcp_f32 v155, v155
    v_pk_mul_f32 v[56:57], v[56:57], v[152:153]
    v_pk_mul_f32 v[58:59], v[58:59], v[154:155]
    v_cvt_pk_bf16_f32 v128, v56, v57
    v_cvt_pk_bf16_f32 v129, v58, v59
    v_pk_mul_f32 v[152:153], v[60:61], v[60:61]
    v_pk_mul_f32 v[154:155], v[62:63], v[62:63]
    v_pk_fma_f32 v[152:153], v[152:153], v[54:55], s[4:5]
    v_pk_fma_f32 v[154:155], v[154:155], v[54:55], s[4:5]
    v_pk_mul_f32 v[152:153], v[60:61], v[152:153]
    v_pk_mul_f32 v[154:155], v[62:63], v[154:155]
    v_exp_f32 v152, v152
    v_exp_f32 v153, v153
    s_waitcnt vmcnt(10)
    ds_read_b64_tr_b16 a[16:17], v14 offset:4096
    ds_read_b64_tr_b16 a[18:19], v14 offset:4608
    ds_read_b64_tr_b16 a[20:21], v15 offset:4096
    ds_read_b64_tr_b16 a[22:23], v15 offset:4608
    s_add_u32 m0, s57, 0
    s_mov_b32 s58, 131072
    buffer_load_dwordx4 v10, s[16:19], s58 offen lds
    buffer_load_dwordx4 v11, s[16:19], s58 offen offset:1024 lds
    v_exp_f32 v154, v154
    v_exp_f32 v155, v155
    v_pk_add_f32 v[152:153], v[152:153], 1.0 op_sel_hi:[1,0]
    v_pk_add_f32 v[154:155], v[154:155], 1.0 op_sel_hi:[1,0]
    v_rcp_f32 v152, v152
    v_rcp_f32 v153, v153
    v_rcp_f32 v154, v154
    v_rcp_f32 v155, v155
    v_pk_mul_f32 v[60:61], v[60:61], v[152:153]
    v_pk_mul_f32 v[62:63], v[62:63], v[154:155]
    v_cvt_pk_bf16_f32 v130, v60, v61
    v_cvt_pk_bf16_f32 v131, v62, v63
    v_pk_mul_f32 v[152:153], v[64:65], v[64:65]
    v_pk_mul_f32 v[154:155], v[66:67], v[66:67]
    s_waitcnt vmcnt(10)
    ds_read_b64_tr_b16 a[24:25], v14 offset:6144
    ds_read_b64_tr_b16 a[26:27], v14 offset:6656
    ds_read_b64_tr_b16 a[28:29], v15 offset:6144
    ds_read_b64_tr_b16 a[30:31], v15 offset:6656
    s_waitcnt lgkmcnt(8)
    s_add_u32 m0, s57, 2048
    s_mov_b32 s58, 139264
    buffer_load_dwordx4 v10, s[16:19], s58 offen lds
    buffer_load_dwordx4 v11, s[16:19], s58 offen offset:1024 lds
    v_pk_fma_f32 v[152:153], v[152:153], v[54:55], s[4:5]
    v_pk_fma_f32 v[154:155], v[154:155], v[54:55], s[4:5]
    v_pk_mul_f32 v[152:153], v[64:65], v[152:153]
    v_pk_mul_f32 v[154:155], v[66:67], v[154:155]
    v_exp_f32 v152, v152
    v_exp_f32 v153, v153
    v_exp_f32 v154, v154
    v_exp_f32 v155, v155
    v_pk_add_f32 v[152:153], v[152:153], 1.0 op_sel_hi:[1,0]
    v_pk_add_f32 v[154:155], v[154:155], 1.0 op_sel_hi:[1,0]
    v_rcp_f32 v152, v152
    v_rcp_f32 v153, v153
    v_rcp_f32 v154, v154
    v_rcp_f32 v155, v155
    s_waitcnt vmcnt(10)
    ds_read_b64_tr_b16 a[32:33], v14 offset:8192
    ds_read_b64_tr_b16 a[34:35], v14 offset:8704
    ds_read_b64_tr_b16 a[36:37], v15 offset:8192
    ds_read_b64_tr_b16 a[38:39], v15 offset:8704
    s_waitcnt lgkmcnt(8)
    s_add_u32 m0, s57, 4096
    s_mov_b32 s58, 163840
    buffer_load_dwordx4 v10, s[16:19], s58 offen lds
    buffer_load_dwordx4 v11, s[16:19], s58 offen offset:1024 lds
    v_pk_mul_f32 v[64:65], v[64:65], v[152:153]
    v_pk_mul_f32 v[66:67], v[66:67], v[154:155]
    v_cvt_pk_bf16_f32 v132, v64, v65
    v_cvt_pk_bf16_f32 v133, v66, v67
    v_pk_mul_f32 v[152:153], v[68:69], v[68:69]
    v_pk_mul_f32 v[154:155], v[70:71], v[70:71]
    v_pk_fma_f32 v[152:153], v[152:153], v[54:55], s[4:5]
    v_pk_fma_f32 v[154:155], v[154:155], v[54:55], s[4:5]
    v_pk_mul_f32 v[152:153], v[68:69], v[152:153]
    v_pk_mul_f32 v[154:155], v[70:71], v[154:155]
    v_exp_f32 v152, v152
    v_exp_f32 v153, v153
    v_exp_f32 v154, v154
    v_exp_f32 v155, v155
    s_waitcnt lgkmcnt(4)
    s_add_u32 m0, s57, 6144
    s_mov_b32 s58, 172032
    buffer_load_dwordx4 v10, s[16:19], s58 offen lds
    buffer_load_dwordx4 v11, s[16:19], s58 offen offset:1024 lds
    v_pk_add_f32 v[152:153], v[152:153], 1.0 op_sel_hi:[1,0]
    v_pk_add_f32 v[154:155], v[154:155], 1.0 op_sel_hi:[1,0]
    v_rcp_f32 v152, v152
    v_rcp_f32 v153, v153
    v_rcp_f32 v154, v154
    v_rcp_f32 v155, v155
    v_pk_mul_f32 v[68:69], v[68:69], v[152:153]
    v_pk_mul_f32 v[70:71], v[70:71], v[154:155]
    v_cvt_pk_bf16_f32 v134, v68, v69
    v_cvt_pk_bf16_f32 v135, v70, v71
    ds_write_b128 v42, v[128:131]
    ds_write_b128 v42, v[132:135] offset:32
    v_pk_mul_f32 v[152:153], v[72:73], v[72:73]
    v_pk_mul_f32 v[154:155], v[74:75], v[74:75]
    s_waitcnt vmcnt(12)
    ds_read_b64_tr_b16 a[40:41], v14 offset:10240
    ds_read_b64_tr_b16 a[42:43], v14 offset:10752
    ds_read_b64_tr_b16 a[44:45], v15 offset:10240
    ds_read_b64_tr_b16 a[46:47], v15 offset:10752
    s_waitcnt lgkmcnt(6)
    s_add_u32 m0, s57, 8192
    s_mov_b32 s58, 196608
    buffer_load_dwordx4 v10, s[16:19], s58 offen lds
    buffer_load_dwordx4 v11, s[16:19], s58 offen offset:1024 lds
    v_pk_fma_f32 v[152:153], v[152:153], v[54:55], s[4:5]
    v_pk_fma_f32 v[154:155], v[154:155], v[54:55], s[4:5]
    v_pk_mul_f32 v[152:153], v[72:73], v[152:153]
    v_pk_mul_f32 v[154:155], v[74:75], v[154:155]
    v_exp_f32 v152, v152
    v_exp_f32 v153, v153
    v_exp_f32 v154, v154
    v_exp_f32 v155, v155
    v_pk_add_f32 v[152:153], v[152:153], 1.0 op_sel_hi:[1,0]
    v_pk_add_f32 v[154:155], v[154:155], 1.0 op_sel_hi:[1,0]
    v_rcp_f32 v152, v152
    v_rcp_f32 v153, v153
    v_rcp_f32 v154, v154
    v_rcp_f32 v155, v155
    s_waitcnt vmcnt(12)
    ds_read_b64_tr_b16 a[48:49], v14 offset:12288
    ds_read_b64_tr_b16 a[50:51], v14 offset:12800
    ds_read_b64_tr_b16 a[52:53], v15 offset:12288
    ds_read_b64_tr_b16 a[54:55], v15 offset:12800
    s_waitcnt lgkmcnt(4)
    s_add_u32 m0, s57, 10240
    s_mov_b32 s58, 204800
    buffer_load_dwordx4 v10, s[16:19], s58 offen lds
    buffer_load_dwordx4 v11, s[16:19], s58 offen offset:1024 lds
    v_pk_mul_f32 v[72:73], v[72:73], v[152:153]
    v_pk_mul_f32 v[74:75], v[74:75], v[154:155]
    v_cvt_pk_bf16_f32 v136, v72, v73
    v_cvt_pk_bf16_f32 v137, v74, v75
    v_pk_mul_f32 v[152:153], v[76:77], v[76:77]
    v_pk_mul_f32 v[154:155], v[78:79], v[78:79]
    v_pk_fma_f32 v[152:153], v[152:153], v[54:55], s[4:5]
    v_pk_fma_f32 v[154:155], v[154:155], v[54:55], s[4:5]
    v_pk_mul_f32 v[152:153], v[76:77], v[152:153]
    v_pk_mul_f32 v[154:155], v[78:79], v[154:155]
    v_exp_f32 v152, v152
    v_exp_f32 v153, v153
    v_exp_f32 v154, v154
    v_exp_f32 v155, v155
    v_pk_add_f32 v[152:153], v[152:153], 1.0 op_sel_hi:[1,0]
    v_pk_add_f32 v[154:155], v[154:155], 1.0 op_sel_hi:[1,0]
    v_rcp_f32 v152, v152
    v_rcp_f32 v153, v153
    v_rcp_f32 v154, v154
    v_rcp_f32 v155, v155
    v_pk_mul_f32 v[76:77], v[76:77], v[152:153]
    v_pk_mul_f32 v[78:79], v[78:79], v[154:155]
    v_cvt_pk_bf16_f32 v138, v76, v77
    v_cvt_pk_bf16_f32 v139, v78, v79
    v_pk_mul_f32 v[152:153], v[80:81], v[80:81]
    v_pk_mul_f32 v[154:155], v[82:83], v[82:83]
    v_pk_fma_f32 v[152:153], v[152:153], v[54:55], s[4:5]
    v_pk_fma_f32 v[154:155], v[154:155], v[54:55], s[4:5]
    s_waitcnt vmcnt(12)
    ds_read_b64_tr_b16 v[88:89], v14 offset:14336
    ds_read_b64_tr_b16 v[90:91], v14 offset:14848
    ds_read_b64_tr_b16 v[92:93], v15 offset:14336
    ds_read_b64_tr_b16 v[94:95], v15 offset:14848
    s_waitcnt lgkmcnt(4)
    s_add_u32 m0, s57, 12288
    s_mov_b32 s58, 229376
    buffer_load_dwordx4 v10, s[16:19], s58 offen lds
    buffer_load_dwordx4 v11, s[16:19], s58 offen offset:1024 lds
    v_pk_mul_f32 v[152:153], v[80:81], v[152:153]
    v_pk_mul_f32 v[154:155], v[82:83], v[154:155]
    v_exp_f32 v152, v152
    v_exp_f32 v153, v153
    v_exp_f32 v154, v154
    v_exp_f32 v155, v155
    v_pk_add_f32 v[152:153], v[152:153], 1.0 op_sel_hi:[1,0]
    v_pk_add_f32 v[154:155], v[154:155], 1.0 op_sel_hi:[1,0]
    v_rcp_f32 v152, v152
    v_rcp_f32 v153, v153
    v_rcp_f32 v154, v154
    v_rcp_f32 v155, v155
    v_pk_mul_f32 v[80:81], v[80:81], v[152:153]
    v_pk_mul_f32 v[82:83], v[82:83], v[154:155]
    v_cvt_pk_bf16_f32 v140, v80, v81
    v_cvt_pk_bf16_f32 v141, v82, v83
    v_pk_mul_f32 v[152:153], v[84:85], v[84:85]
    v_pk_mul_f32 v[154:155], v[86:87], v[86:87]
    v_pk_fma_f32 v[152:153], v[152:153], v[54:55], s[4:5]
    v_pk_fma_f32 v[154:155], v[154:155], v[54:55], s[4:5]
    v_pk_mul_f32 v[152:153], v[84:85], v[152:153]
    v_pk_mul_f32 v[154:155], v[86:87], v[154:155]
    v_exp_f32 v152, v152
    v_exp_f32 v153, v153
    v_exp_f32 v154, v154
    v_exp_f32 v155, v155
    v_pk_add_f32 v[152:153], v[152:153], 1.0 op_sel_hi:[1,0]
    v_pk_add_f32 v[154:155], v[154:155], 1.0 op_sel_hi:[1,0]
    s_waitcnt vmcnt(12)
    ds_read_b64_tr_b16 v[96:97], v14
    ds_read_b64_tr_b16 v[98:99], v14 offset:512
    ds_read_b64_tr_b16 v[100:101], v15
    ds_read_b64_tr_b16 v[102:103], v15 offset:512
    s_waitcnt lgkmcnt(4)
    s_add_u32 m0, s57, 14336
    s_mov_b32 s58, 237568
    buffer_load_dwordx4 v10, s[16:19], s58 offen lds
    buffer_load_dwordx4 v11, s[16:19], s58 offen offset:1024 lds
    v_rcp_f32 v152, v152
    v_rcp_f32 v153, v153
    v_rcp_f32 v154, v154
    v_rcp_f32 v155, v155
    v_pk_mul_f32 v[84:85], v[84:85], v[152:153]
    v_pk_mul_f32 v[86:87], v[86:87], v[154:155]
    v_cvt_pk_bf16_f32 v142, v84, v85
    v_cvt_pk_bf16_f32 v143, v86, v87
    ds_write_b128 v42, v[136:139] offset:8448
    ds_write_b128 v42, v[140:143] offset:8480
    v_pk_mul_f32 v[152:153], v[120:121], v[120:121]
    v_pk_mul_f32 v[154:155], v[122:123], v[122:123]
    v_pk_fma_f32 v[152:153], v[152:153], v[54:55], s[4:5]
    v_pk_fma_f32 v[154:155], v[154:155], v[54:55], s[4:5]
    s_waitcnt vmcnt(12)
    ds_read_b64_tr_b16 v[104:105], v14 offset:2048
    ds_read_b64_tr_b16 v[106:107], v14 offset:2560
    ds_read_b64_tr_b16 v[108:109], v15 offset:2048
    ds_read_b64_tr_b16 v[110:111], v15 offset:2560
    s_waitcnt lgkmcnt(6)
    s_add_u32 m0, s57, 0
    s_mov_b32 s58, 262144
    buffer_load_dwordx4 v10, s[16:19], s58 offen lds
    buffer_load_dwordx4 v11, s[16:19], s58 offen offset:1024 lds
    v_pk_mul_f32 v[152:153], v[120:121], v[152:153]
    v_pk_mul_f32 v[154:155], v[122:123], v[154:155]
    v_exp_f32 v152, v152
    v_exp_f32 v153, v153
    v_exp_f32 v154, v154
    v_exp_f32 v155, v155
    v_pk_add_f32 v[152:153], v[152:153], 1.0 op_sel_hi:[1,0]
    v_pk_add_f32 v[154:155], v[154:155], 1.0 op_sel_hi:[1,0]
    v_rcp_f32 v152, v152
    v_rcp_f32 v153, v153
    v_rcp_f32 v154, v154
    v_rcp_f32 v155, v155
    v_pk_mul_f32 v[120:121], v[120:121], v[152:153]
    v_pk_mul_f32 v[122:123], v[122:123], v[154:155]
    s_waitcnt vmcnt(12)
    ds_read_b64_tr_b16 v[112:113], v14 offset:4096
    ds_read_b64_tr_b16 v[114:115], v14 offset:4608
    ds_read_b64_tr_b16 v[116:117], v15 offset:4096
    ds_read_b64_tr_b16 v[118:119], v15 offset:4608
    s_waitcnt lgkmcnt(4)
    s_add_u32 m0, s57, 2048
    s_mov_b32 s58, 270336
    buffer_load_dwordx4 v10, s[16:19], s58 offen lds
    buffer_load_dwordx4 v11, s[16:19], s58 offen offset:1024 lds
    v_cvt_pk_bf16_f32 v144, v120, v121
    v_cvt_pk_bf16_f32 v145, v122, v123
    v_pk_mul_f32 v[152:153], v[124:125], v[124:125]
    v_pk_mul_f32 v[154:155], v[126:127], v[126:127]
    v_pk_fma_f32 v[152:153], v[152:153], v[54:55], s[4:5]
    v_pk_fma_f32 v[154:155], v[154:155], v[54:55], s[4:5]
    v_pk_mul_f32 v[152:153], v[124:125], v[152:153]
    v_pk_mul_f32 v[154:155], v[126:127], v[154:155]
    v_exp_f32 v152, v152
    v_exp_f32 v153, v153
    v_exp_f32 v154, v154
    v_exp_f32 v155, v155
    v_pk_add_f32 v[152:153], v[152:153], 1.0 op_sel_hi:[1,0]
    v_pk_add_f32 v[154:155], v[154:155], 1.0 op_sel_hi:[1,0]
    s_waitcnt vmcnt(12)
    ds_read_b64_tr_b16 a[88:89], v14 offset:6144
    ds_read_b64_tr_b16 a[90:91], v14 offset:6656
    ds_read_b64_tr_b16 a[92:93], v15 offset:6144
    ds_read_b64_tr_b16 a[94:95], v15 offset:6656
    s_waitcnt lgkmcnt(4)
    s_add_u32 m0, s57, 4096
    s_mov_b32 s58, 294912
    buffer_load_dwordx4 v10, s[16:19], s58 offen lds
    buffer_load_dwordx4 v11, s[16:19], s58 offen offset:1024 lds
    v_rcp_f32 v152, v152
    v_rcp_f32 v153, v153
    v_rcp_f32 v154, v154
    v_rcp_f32 v155, v155
    v_pk_mul_f32 v[124:125], v[124:125], v[152:153]
    v_pk_mul_f32 v[126:127], v[126:127], v[154:155]
    v_cvt_pk_bf16_f32 v146, v124, v125
    v_cvt_pk_bf16_f32 v147, v126, v127
    ds_write_b64 v43, v[144:145]
    ds_write_b64 v43, v[146:147] offset:64
    s_waitcnt lgkmcnt(0)
    s_barrier
    ds_read_b128 a[64:67], v44
    ds_read_b128 a[68:71], v44 offset:32
    s_waitcnt lgkmcnt(1)
    v_mfma_f32_32x32x16_bf16 v[56:71], a[0:3], a[64:67], 0
    ds_read_b128 a[72:75], v44 offset:128
    s_waitcnt vmcnt(12)
    ds_read_b64_tr_b16 a[80:81], v14 offset:8192
    ds_read_b64_tr_b16 a[82:83], v14 offset:8704
    ds_read_b64_tr_b16 a[84:85], v15 offset:8192
    ds_read_b64_tr_b16 a[86:87], v15 offset:8704
    v_mfma_f32_32x32x16_bf16 v[72:87], a[4:7], a[64:67], 0
    s_add_u32 m0, s57, 6144
    s_mov_b32 s58, 303104
    buffer_load_dwordx4 v10, s[16:19], s58 offen lds
    buffer_load_dwordx4 v11, s[16:19], s58 offen offset:1024 lds
    s_waitcnt lgkmcnt(5)
    v_mfma_f32_32x32x16_bf16 v[56:71], a[8:11], a[68:71], v[56:71]
    ds_read_b128 a[76:79], v44 offset:160
    v_mfma_f32_32x32x16_bf16 v[72:87], a[12:15], a[68:71], v[72:87]
    s_waitcnt lgkmcnt(5)
    v_mfma_f32_32x32x16_bf16 v[56:71], a[16:19], a[72:75], v[56:71]
    ds_read_b128 a[64:67], v44 offset:256
    s_waitcnt vmcnt(12)
    ds_read_b64_tr_b16 a[56:57], v14 offset:10240
    ds_read_b64_tr_b16 a[58:59], v14 offset:10752
    ds_read_b64_tr_b16 a[60:61], v15 offset:10240
    ds_read_b64_tr_b16 a[62:63], v15 offset:10752
    v_mfma_f32_32x32x16_bf16 v[72:87], a[20:23], a[72:75], v[72:87]
    s_waitcnt lgkmcnt(6)
    s_add_u32 m0, s57, 8192
    s_mov_b32 s58, 327680
    buffer_load_dwordx4 v10, s[16:19], s58 offen lds
    buffer_load_dwordx4 v11, s[16:19], s58 offen offset:1024 lds
    s_waitcnt lgkmcnt(5)
    v_mfma_f32_32x32x16_bf16 v[56:71], a[24:27], a[76:79], v[56:71]
    ds_read_b128 a[68:71], v44 offset:288
    v_mfma_f32_32x32x16_bf16 v[72:87], a[28:31], a[76:79], v[72:87]
    s_waitcnt lgkmcnt(5)
    v_mfma_f32_32x32x16_bf16 v[56:71], a[32:35], a[64:67], v[56:71]
    ds_read_b128 a[72:75], v44 offset:384
    s_waitcnt vmcnt(12)
    ds_read_b64_tr_b16 a[0:1], v14 offset:12288
    ds_read_b64_tr_b16 a[2:3], v14 offset:12800
    ds_read_b64_tr_b16 a[4:5], v15 offset:12288
    ds_read_b64_tr_b16 a[6:7], v15 offset:12800
    v_mfma_f32_32x32x16_bf16 v[72:87], a[36:39], a[64:67], v[72:87]
    s_waitcnt lgkmcnt(6)
    s_add_u32 m0, s57, 10240
    s_mov_b32 s58, 335872
    buffer_load_dwordx4 v10, s[16:19], s58 offen lds
    buffer_load_dwordx4 v11, s[16:19], s58 offen offset:1024 lds
    s_waitcnt lgkmcnt(5)
    v_mfma_f32_32x32x16_bf16 v[56:71], a[40:43], a[68:71], v[56:71]
    ds_read_b128 a[76:79], v44 offset:416
    v_mfma_f32_32x32x16_bf16 v[72:87], a[44:47], a[68:71], v[72:87]
    s_waitcnt lgkmcnt(5)
    v_mfma_f32_32x32x16_bf16 v[56:71], a[48:51], a[72:75], v[56:71]
    ds_read_b128 a[64:67], v44 offset:19536
    v_mfma_f32_32x32x16_bf16 v[72:87], a[52:55], a[72:75], v[72:87]
    s_waitcnt lgkmcnt(1)
    v_mfma_f32_32x32x16_bf16 v[56:71], v[88:91], a[76:79], v[56:71]
    ds_read_b128 a[68:71], v44 offset:19568
    s_waitcnt vmcnt(12)
    ds_read_b64_tr_b16 a[8:9], v14 offset:14336
    ds_read_b64_tr_b16 a[10:11], v14 offset:14848
    ds_read_b64_tr_b16 a[12:13], v15 offset:14336
    ds_read_b64_tr_b16 a[14:15], v15 offset:14848
    v_mfma_f32_32x32x16_bf16 v[72:87], v[92:95], a[76:79], v[72:87]
    s_add_u32 m0, s57, 12288
    s_mov_b32 s58, 360448
    buffer_load_dwordx4 v10, s[16:19], s58 offen lds
    buffer_load_dwordx4 v11, s[16:19], s58 offen offset:1024 lds
    s_waitcnt lgkmcnt(5)
    v_mfma_f32_32x32x16_bf16 v[56:71], v[96:99], a[64:67], v[56:71]
    ds_read_b128 a[72:75], v44 offset:19664
    v_mfma_f32_32x32x16_bf16 v[72:87], v[100:103], a[64:67], v[72:87]
    s_waitcnt lgkmcnt(5)
    v_mfma_f32_32x32x16_bf16 v[56:71], v[104:107], a[68:71], v[56:71]
    ds_read_b128 a[76:79], v44 offset:19696
    s_waitcnt vmcnt(12)
    ds_read_b64_tr_b16 a[16:17], v14
    ds_read_b64_tr_b16 a[18:19], v14 offset:512
    ds_read_b64_tr_b16 a[20:21], v15
    ds_read_b64_tr_b16 a[22:23], v15 offset:512
    v_mfma_f32_32x32x16_bf16 v[72:87], v[108:111], a[68:71], v[72:87]
    s_waitcnt lgkmcnt(6)
    s_add_u32 m0, s57, 14336
    s_mov_b32 s58, 368640
    buffer_load_dwordx4 v10, s[16:19], s58 offen lds
    buffer_load_dwordx4 v11, s[16:19], s58 offen offset:1024 lds
    s_waitcnt lgkmcnt(5)
    v_mfma_f32_32x32x16_bf16 v[56:71], v[112:115], a[72:75], v[56:71]
    ds_read_b128 a[64:67], v44 offset:19792
    v_mfma_f32_32x32x16_bf16 v[72:87], v[116:119], a[72:75], v[72:87]
    s_waitcnt lgkmcnt(5)
    v_mfma_f32_32x32x16_bf16 v[56:71], a[88:91], a[76:79], v[56:71]
    ds_read_b128 a[68:71], v44 offset:19824
    v_mfma_f32_32x32x16_bf16 v[72:87], a[92:95], a[76:79], v[72:87]
    s_waitcnt vmcnt(12)
    ds_read_b64_tr_b16 a[24:25], v14 offset:2048
    ds_read_b64_tr_b16 a[26:27], v14 offset:2560
    ds_read_b64_tr_b16 a[28:29], v15 offset:2048
    ds_read_b64_tr_b16 a[30:31], v15 offset:2560
    s_waitcnt lgkmcnt(6)
    s_add_u32 m0, s57, 0
    s_mov_b32 s58, 16384
    buffer_load_dwordx4 v10, s[16:19], s58 offen lds
    buffer_load_dwordx4 v11, s[16:19], s58 offen offset:1024 lds
    s_waitcnt lgkmcnt(5)
    v_mfma_f32_32x32x16_bf16 v[56:71], a[80:83], a[64:67], v[56:71]
    ds_read_b128 a[72:75], v44 offset:19920
    v_mfma_f32_32x32x16_bf16 v[72:87], a[84:87], a[64:67], v[72:87]
    s_waitcnt lgkmcnt(5)
    v_mfma_f32_32x32x16_bf16 v[56:71], a[56:59], a[68:71], v[56:71]
    ds_read_b128 a[76:79], v44 offset:19952
    s_waitcnt vmcnt(12)
    ds_read_b64_tr_b16 a[32:33], v14 offset:4096
    ds_read_b64_tr_b16 a[34:35], v14 offset:4608
    ds_read_b64_tr_b16 a[36:37], v15 offset:4096
    ds_read_b64_tr_b16 a[38:39], v15 offset:4608
    v_mfma_f32_32x32x16_bf16 v[72:87], a[60:63], a[68:71], v[72:87]
    s_waitcnt lgkmcnt(6)
    s_add_u32 m0, s57, 2048
    s_mov_b32 s58, 24576
    buffer_load_dwordx4 v10, s[16:19], s58 offen lds
    buffer_load_dwordx4 v11, s[16:19], s58 offen offset:1024 lds
    s_waitcnt lgkmcnt(5)
    v_mfma_f32_32x32x16_bf16 v[56:71], a[0:3], a[72:75], v[56:71]
    ds_read_b128 a[64:67], v44 offset:528
    v_mfma_f32_32x32x16_bf16 v[72:87], a[4:7], a[72:75], v[72:87]
    s_waitcnt lgkmcnt(5)
    v_mfma_f32_32x32x16_bf16 v[56:71], a[8:11], a[76:79], v[56:71]
    ds_read_b128 a[68:71], v44 offset:560
    v_mfma_f32_32x32x16_bf16 v[72:87], a[12:15], a[76:79], v[72:87]
    s_waitcnt vmcnt(12)
    ds_read_b64_tr_b16 a[40:41], v14 offset:6144
    ds_read_b64_tr_b16 a[42:43], v14 offset:6656
    ds_read_b64_tr_b16 a[44:45], v15 offset:6144
    ds_read_b64_tr_b16 a[46:47], v15 offset:6656
    s_waitcnt lgkmcnt(6)
    s_add_u32 m0, s57, 4096
    s_mov_b32 s58, 49152
    buffer_load_dwordx4 v10, s[16:19], s58 offen lds
    buffer_load_dwordx4 v11, s[16:19], s58 offen offset:1024 lds
    s_waitcnt lgkmcnt(5)
    v_mfma_f32_32x32x16_bf16 v[56:71], a[16:19], a[64:67], v[56:71]
    ds_read_b128 a[72:75], v44 offset:656
    v_mfma_f32_32x32x16_bf16 v[72:87], a[20:23], a[64:67], v[72:87]
    s_waitcnt lgkmcnt(5)
    v_mfma_f32_32x32x16_bf16 v[56:71], a[24:27], a[68:71], v[56:71]
    ds_read_b128 a[76:79], v44 offset:688
    v_mfma_f32_32x32x16_bf16 v[72:87], a[28:31], a[68:71], v[72:87]
    s_waitcnt vmcnt(12)
    ds_read_b64_tr_b16 a[48:49], v14 offset:8192
    ds_read_b64_tr_b16 a[50:51], v14 offset:8704
    ds_read_b64_tr_b16 a[52:53], v15 offset:8192
    ds_read_b64_tr_b16 a[54:55], v15 offset:8704
    s_waitcnt lgkmcnt(6)
    s_add_u32 m0, s57, 6144
    s_mov_b32 s58, 57344
    buffer_load_dwordx4 v10, s[16:19], s58 offen lds
    buffer_load_dwordx4 v11, s[16:19], s58 offen offset:1024 lds
    s_waitcnt lgkmcnt(5)
    v_mfma_f32_32x32x16_bf16 v[56:71], a[32:35], a[72:75], v[56:71]
    ds_read_b128 a[64:67], v44 offset:784
    v_mfma_f32_32x32x16_bf16 v[72:87], a[36:39], a[72:75], v[72:87]
    s_waitcnt lgkmcnt(5)
    v_mfma_f32_32x32x16_bf16 v[56:71], a[40:43], a[76:79], v[56:71]
    ds_read_b128 a[68:71], v44 offset:816
    s_waitcnt vmcnt(12)
    ds_read_b64_tr_b16 a[88:89], v14 offset:10240
    ds_read_b64_tr_b16 a[90:91], v14 offset:10752
    ds_read_b64_tr_b16 a[92:93], v15 offset:10240
    ds_read_b64_tr_b16 a[94:95], v15 offset:10752
    v_mfma_f32_32x32x16_bf16 v[72:87], a[44:47], a[76:79], v[72:87]
    s_waitcnt lgkmcnt(6)
    s_add_u32 m0, s57, 8192
    s_mov_b32 s58, 81920
    buffer_load_dwordx4 v10, s[16:19], s58 offen lds
    buffer_load_dwordx4 v11, s[16:19], s58 offen offset:1024 lds
    s_waitcnt lgkmcnt(5)
    v_mfma_f32_32x32x16_bf16 v[56:71], a[48:51], a[64:67], v[56:71]
    ds_read_b128 a[72:75], v44 offset:912
    v_mfma_f32_32x32x16_bf16 v[72:87], a[52:55], a[64:67], v[72:87]
    s_waitcnt vmcnt(12)
    ds_read_b64_tr_b16 a[80:81], v14 offset:12288
    ds_read_b64_tr_b16 a[82:83], v14 offset:12800
    ds_read_b64_tr_b16 a[84:85], v15 offset:12288
    ds_read_b64_tr_b16 a[86:87], v15 offset:12800
    s_waitcnt lgkmcnt(5)
    s_add_u32 m0, s57, 10240
    s_mov_b32 s58, 90112
    buffer_load_dwordx4 v10, s[16:19], s58 offen lds
    buffer_load_dwordx4 v11, s[16:19], s58 offen offset:1024 lds
    v_mfma_f32_32x32x16_bf16 v[56:71], a[88:91], a[68:71], v[56:71]
    ds_read_b128 a[76:79], v44 offset:944
    v_mfma_f32_32x32x16_bf16 v[72:87], a[92:95], a[68:71], v[72:87]
    s_waitcnt vmcnt(12)
    ds_read_b64_tr_b16 a[56:57], v14 offset:14336
    ds_read_b64_tr_b16 a[58:59], v14 offset:14848
    ds_read_b64_tr_b16 a[60:61], v15 offset:14336
    ds_read_b64_tr_b16 a[62:63], v15 offset:14848
    s_waitcnt lgkmcnt(5)
    s_add_u32 m0, s57, 12288
    s_mov_b32 s58, 114688
    buffer_load_dwordx4 v10, s[16:19], s58 offen lds
    buffer_load_dwordx4 v11, s[16:19], s58 offen offset:1024 lds
    v_mfma_f32_32x32x16_bf16 v[56:71], a[80:83], a[72:75], v[56:71]
    ds_read_b128 a[64:67], v44 offset:64
    v_mfma_f32_32x32x16_bf16 v[72:87], a[84:87], a[72:75], v[72:87]
    s_waitcnt vmcnt(12)
    ds_read_b64_tr_b16 a[0:1], v14
    ds_read_b64_tr_b16 a[2:3], v14 offset:512
    ds_read_b64_tr_b16 a[4:5], v15
    ds_read_b64_tr_b16 a[6:7], v15 offset:512
    s_waitcnt lgkmcnt(5)
    s_add_u32 m0, s57, 14336
    s_mov_b32 s58, 122880
    buffer_load_dwordx4 v10, s[16:19], s58 offen lds
    buffer_load_dwordx4 v11, s[16:19], s58 offen offset:1024 lds
    v_mfma_f32_32x32x16_bf16 v[56:71], a[56:59], a[76:79], v[56:71]
    v_and_b32 v2, 31, v1
    v_lshrrev_b32 v3, 5, v1
    s_mul_i32 s65, s56, 1040
    v_lshlrev_b32 v4, 4, v2
    v_add_u32 v50, s65, v4
    v_lshl_add_u32 v5, v3, 12, v4
    v_add_u32 v51, 135168, v5
    s_mul_i32 s65, s56, 4224
    v_mul_u32_u24 v5, 2112, v3
    v_add3_u32 v5, v5, v4, s65
    v_add_u32 v18, 33280, v5
    v_add_u32 v19, 50176, v5
    v_add_u32 v20, 143392, v5
    ds_read_b128 a[68:71], v44 offset:96
    v_mfma_f32_32x32x16_bf16 v[72:87], a[60:63], a[76:79], v[72:87]
    s_waitcnt vmcnt(12)
    ds_read_b64_tr_b16 a[8:9], v14 offset:2048
    ds_read_b64_tr_b16 a[10:11], v14 offset:2560
    ds_read_b64_tr_b16 a[12:13], v15 offset:2048
    ds_read_b64_tr_b16 a[14:15], v15 offset:2560
    s_waitcnt lgkmcnt(5)
    s_add_u32 m0, s57, 0
    s_mov_b32 s58, 147456
    buffer_load_dwordx4 v10, s[16:19], s58 offen lds
    buffer_load_dwordx4 v11, s[16:19], s58 offen offset:1024 lds
    v_mfma_f32_32x32x16_bf16 v[56:71], a[0:3], a[64:67], v[56:71]
    ds_read_b128 a[72:75], v44 offset:192
    v_mfma_f32_32x32x16_bf16 v[72:87], a[4:7], a[64:67], v[72:87]
    s_waitcnt vmcnt(12)
    ds_read_b64_tr_b16 a[16:17], v14 offset:4096
    ds_read_b64_tr_b16 a[18:19], v14 offset:4608
    ds_read_b64_tr_b16 a[20:21], v15 offset:4096
    ds_read_b64_tr_b16 a[22:23], v15 offset:4608
    s_waitcnt lgkmcnt(5)
    s_add_u32 m0, s57, 2048
    s_mov_b32 s58, 155648
    buffer_load_dwordx4 v10, s[16:19], s58 offen lds
    buffer_load_dwordx4 v11, s[16:19], s58 offen offset:1024 lds
    v_mfma_f32_32x32x16_bf16 v[56:71], a[8:11], a[68:71], v[56:71]
    ds_read_b128 a[76:79], v44 offset:224
    v_mfma_f32_32x32x16_bf16 v[72:87], a[12:15], a[68:71], v[72:87]
    s_waitcnt vmcnt(12)
    ds_read_b64_tr_b16 a[24:25], v14 offset:6144
    ds_read_b64_tr_b16 a[26:27], v14 offset:6656
    ds_read_b64_tr_b16 a[28:29], v15 offset:6144
    ds_read_b64_tr_b16 a[30:31], v15 offset:6656
    s_waitcnt lgkmcnt(5)
    s_add_u32 m0, s57, 4096
    s_mov_b32 s58, 180224
    buffer_load_dwordx4 v10, s[16:19], s58 offen lds
    buffer_load_dwordx4 v11, s[16:19], s58 offen offset:1024 lds
    v_mfma_f32_32x32x16_bf16 v[56:71], a[16:19], a[72:75], v[56:71]
    ds_read_b128 a[64:67], v44 offset:320
    v_mfma_f32_32x32x16_bf16 v[72:87], a[20:23], a[72:75], v[72:87]
    s_waitcnt vmcnt(12)
    ds_read_b64_tr_b16 a[32:33], v14 offset:8192
    ds_read_b64_tr_b16 a[34:35], v14 offset:8704
    ds_read_b64_tr_b16 a[36:37], v15 offset:8192
    ds_read_b64_tr_b16 a[38:39], v15 offset:8704
    s_waitcnt lgkmcnt(5)
    s_add_u32 m0, s57, 6144
    s_mov_b32 s58, 188416
    buffer_load_dwordx4 v10, s[16:19], s58 offen lds
    buffer_load_dwordx4 v11, s[16:19], s58 offen offset:1024 lds
    v_mfma_f32_32x32x16_bf16 v[56:71], a[24:27], a[76:79], v[56:71]
    ds_read_b128 a[68:71], v44 offset:352
    v_mfma_f32_32x32x16_bf16 v[72:87], a[28:31], a[76:79], v[72:87]
    s_waitcnt vmcnt(12)
    ds_read_b64_tr_b16 a[40:41], v14 offset:10240
    ds_read_b64_tr_b16 a[42:43], v14 offset:10752
    ds_read_b64_tr_b16 a[44:45], v15 offset:10240
    ds_read_b64_tr_b16 a[46:47], v15 offset:10752
    s_waitcnt lgkmcnt(5)
    s_add_u32 m0, s57, 8192
    s_mov_b32 s58, 212992
    buffer_load_dwordx4 v10, s[16:19], s58 offen lds
    buffer_load_dwordx4 v11, s[16:19], s58 offen offset:1024 lds
    v_mfma_f32_32x32x16_bf16 v[56:71], a[32:35], a[64:67], v[56:71]
    ds_read_b128 a[72:75], v44 offset:448
    v_mfma_f32_32x32x16_bf16 v[72:87], a[36:39], a[64:67], v[72:87]
    s_waitcnt vmcnt(12)
    ds_read_b64_tr_b16 a[48:49], v14 offset:12288
    ds_read_b64_tr_b16 a[50:51], v14 offset:12800
    ds_read_b64_tr_b16 a[52:53], v15 offset:12288
    ds_read_b64_tr_b16 a[54:55], v15 offset:12800
    s_waitcnt lgkmcnt(5)
    s_add_u32 m0, s57, 10240
    s_mov_b32 s58, 221184
    buffer_load_dwordx4 v10, s[16:19], s58 offen lds
    buffer_load_dwordx4 v11, s[16:19], s58 offen offset:1024 lds
    v_mfma_f32_32x32x16_bf16 v[56:71], a[40:43], a[68:71], v[56:71]
    ds_read_b128 a[76:79], v44 offset:480
    v_mfma_f32_32x32x16_bf16 v[72:87], a[44:47], a[68:71], v[72:87]
    s_waitcnt vmcnt(12)
    ds_read_b64_tr_b16 a[88:89], v14 offset:14336
    ds_read_b64_tr_b16 a[90:91], v14 offset:14848
    ds_read_b64_tr_b16 a[92:93], v15 offset:14336
    ds_read_b64_tr_b16 a[94:95], v15 offset:14848
    s_waitcnt lgkmcnt(5)
    s_add_u32 m0, s57, 12288
    s_mov_b32 s58, 245760
    buffer_load_dwordx4 v10, s[16:19], s58 offen lds
    buffer_load_dwordx4 v11, s[16:19], s58 offen offset:1024 lds
    v_mfma_f32_32x32x16_bf16 v[56:71], a[48:51], a[72:75], v[56:71]
    ds_read_b128 a[64:67], v44 offset:19600
    v_mfma_f32_32x32x16_bf16 v[72:87], a[52:55], a[72:75], v[72:87]
    s_waitcnt vmcnt(12)
    ds_read_b64_tr_b16 a[80:81], v14
    ds_read_b64_tr_b16 a[82:83], v14 offset:512
    ds_read_b64_tr_b16 a[84:85], v15
    ds_read_b64_tr_b16 a[86:87], v15 offset:512
    s_waitcnt lgkmcnt(5)
    s_add_u32 m0, s57, 14336
    s_mov_b32 s58, 253952
    buffer_load_dwordx4 v10, s[16:19], s58 offen lds
    buffer_load_dwordx4 v11, s[16:19], s58 offen offset:1024 lds
    v_mfma_f32_32x32x16_bf16 v[56:71], a[88:91], a[76:79], v[56:71]
    ds_read_b128 a[68:71], v44 offset:19632
    v_mfma_f32_32x32x16_bf16 v[72:87], a[92:95], a[76:79], v[72:87]
    s_waitcnt vmcnt(12)
    ds_read_b64_tr_b16 a[56:57], v14 offset:2048
    ds_read_b64_tr_b16 a[58:59], v14 offset:2560
    ds_read_b64_tr_b16 a[60:61], v15 offset:2048
    ds_read_b64_tr_b16 a[62:63], v15 offset:2560
    s_waitcnt lgkmcnt(5)
    s_add_u32 m0, s57, 0
    s_mov_b32 s58, 278528
    buffer_load_dwordx4 v10, s[16:19], s58 offen lds
    buffer_load_dwordx4 v11, s[16:19], s58 offen offset:1024 lds
    v_mfma_f32_32x32x16_bf16 v[56:71], a[80:83], a[64:67], v[56:71]
    ds_read_b128 a[72:75], v44 offset:19728
    v_mfma_f32_32x32x16_bf16 v[72:87], a[84:87], a[64:67], v[72:87]
    s_waitcnt vmcnt(12)
    ds_read_b64_tr_b16 a[0:1], v14 offset:4096
    ds_read_b64_tr_b16 a[2:3], v14 offset:4608
    ds_read_b64_tr_b16 a[4:5], v15 offset:4096
    ds_read_b64_tr_b16 a[6:7], v15 offset:4608
    s_waitcnt lgkmcnt(5)
    s_add_u32 m0, s57, 2048
    s_mov_b32 s58, 286720
    buffer_load_dwordx4 v10, s[16:19], s58 offen lds
    buffer_load_dwordx4 v11, s[16:19], s58 offen offset:1024 lds
    v_mfma_f32_32x32x16_bf16 v[56:71], a[56:59], a[68:71], v[56:71]
    ds_read_b128 a[76:79], v44 offset:19760
    v_mfma_f32_32x32x16_bf16 v[72:87], a[60:63], a[68:71], v[72:87]
    s_waitcnt vmcnt(12)
    ds_read_b64_tr_b16 a[8:9], v14 offset:6144
    ds_read_b64_tr_b16 a[10:11], v14 offset:6656
    ds_read_b64_tr_b16 a[12:13], v15 offset:6144
    ds_read_b64_tr_b16 a[14:15], v15 offset:6656
    s_waitcnt lgkmcnt(5)
    s_add_u32 m0, s57, 4096
    s_mov_b32 s58, 311296
    buffer_load_dwordx4 v10, s[16:19], s58 offen lds
    buffer_load_dwordx4 v11, s[16:19], s58 offen offset:1024 lds
    v_mfma_f32_32x32x16_bf16 v[56:71], a[0:3], a[72:75], v[56:71]
    ds_read_b128 a[64:67], v44 offset:19856
    v_mfma_f32_32x32x16_bf16 v[72:87], a[4:7], a[72:75], v[72:87]
    s_waitcnt vmcnt(12)
    ds_read_b64_tr_b16 a[16:17], v14 offset:8192
    ds_read_b64_tr_b16 a[18:19], v14 offset:8704
    ds_read_b64_tr_b16 a[20:21], v15 offset:8192
    ds_read_b64_tr_b16 a[22:23], v15 offset:8704
    s_waitcnt lgkmcnt(5)
    s_add_u32 m0, s57, 6144
    s_mov_b32 s58, 319488
    buffer_load_dwordx4 v10, s[16:19], s58 offen lds
    buffer_load_dwordx4 v11, s[16:19], s58 offen offset:1024 lds
    v_mfma_f32_32x32x16_bf16 v[56:71], a[8:11], a[76:79], v[56:71]
    ds_read_b128 a[68:71], v44 offset:19888
    v_mfma_f32_32x32x16_bf16 v[72:87], a[12:15], a[76:79], v[72:87]
    s_waitcnt vmcnt(12)
    ds_read_b64_tr_b16 a[24:25], v14 offset:10240
    ds_read_b64_tr_b16 a[26:27], v14 offset:10752
    ds_read_b64_tr_b16 a[28:29], v15 offset:10240
    ds_read_b64_tr_b16 a[30:31], v15 offset:10752
    s_waitcnt lgkmcnt(5)
    s_add_u32 m0, s57, 8192
    s_mov_b32 s58, 344064
    buffer_load_dwordx4 v10, s[16:19], s58 offen lds
    buffer_load_dwordx4 v11, s[16:19], s58 offen offset:1024 lds
    v_mfma_f32_32x32x16_bf16 v[56:71], a[16:19], a[64:67], v[56:71]
    ds_read_b128 a[72:75], v44 offset:19984
    v_mfma_f32_32x32x16_bf16 v[72:87], a[20:23], a[64:67], v[72:87]
    s_waitcnt vmcnt(12)
    ds_read_b64_tr_b16 a[32:33], v14 offset:12288
    ds_read_b64_tr_b16 a[34:35], v14 offset:12800
    ds_read_b64_tr_b16 a[36:37], v15 offset:12288
    ds_read_b64_tr_b16 a[38:39], v15 offset:12800
    s_waitcnt lgkmcnt(5)
    s_add_u32 m0, s57, 10240
    s_mov_b32 s58, 352256
    buffer_load_dwordx4 v10, s[16:19], s58 offen lds
    buffer_load_dwordx4 v11, s[16:19], s58 offen offset:1024 lds
    v_mfma_f32_32x32x16_bf16 v[56:71], a[24:27], a[68:71], v[56:71]
    ds_read_b128 a[76:79], v44 offset:20016
    v_mfma_f32_32x32x16_bf16 v[72:87], a[28:31], a[68:71], v[72:87]
    s_waitcnt vmcnt(12)
    ds_read_b64_tr_b16 a[40:41], v14 offset:14336
    ds_read_b64_tr_b16 a[42:43], v14 offset:14848
    ds_read_b64_tr_b16 a[44:45], v15 offset:14336
    ds_read_b64_tr_b16 a[46:47], v15 offset:14848
    s_waitcnt lgkmcnt(5)
    s_add_u32 m0, s57, 12288
    s_mov_b32 s58, 376832
    buffer_load_dwordx4 v10, s[16:19], s58 offen lds
    buffer_load_dwordx4 v11, s[16:19], s58 offen offset:1024 lds
    v_mfma_f32_32x32x16_bf16 v[56:71], a[32:35], a[72:75], v[56:71]
    ds_read_b128 a[64:67], v44 offset:592
    v_mfma_f32_32x32x16_bf16 v[72:87], a[36:39], a[72:75], v[72:87]
    s_waitcnt vmcnt(12)
    ds_read_b64_tr_b16 a[48:49], v14
    ds_read_b64_tr_b16 a[50:51], v14 offset:512
    ds_read_b64_tr_b16 a[52:53], v15
    ds_read_b64_tr_b16 a[54:55], v15 offset:512
    s_waitcnt lgkmcnt(5)
    s_add_u32 m0, s57, 14336
    s_mov_b32 s58, 385024
    buffer_load_dwordx4 v10, s[16:19], s58 offen lds
    buffer_load_dwordx4 v11, s[16:19], s58 offen offset:1024 lds
    v_mfma_f32_32x32x16_bf16 v[56:71], a[40:43], a[76:79], v[56:71]
    ds_read_b128 a[68:71], v44 offset:624
    v_mfma_f32_32x32x16_bf16 v[72:87], a[44:47], a[76:79], v[72:87]
    s_waitcnt vmcnt(12)
    ds_read_b64_tr_b16 a[88:89], v14 offset:2048
    ds_read_b64_tr_b16 a[90:91], v14 offset:2560
    ds_read_b64_tr_b16 a[92:93], v15 offset:2048
    ds_read_b64_tr_b16 a[94:95], v15 offset:2560
    s_waitcnt lgkmcnt(5)
    s_add_u32 m0, s57, 0
    s_mov_b32 s58, 0
    buffer_load_dwordx4 v10, s[24:27], s58 offen lds
    buffer_load_dwordx4 v11, s[24:27], s58 offen offset:1024 lds
    v_mfma_f32_32x32x16_bf16 v[56:71], a[48:51], a[64:67], v[56:71]
    ds_read_b128 a[72:75], v44 offset:720
    v_mfma_f32_32x32x16_bf16 v[72:87], a[52:55], a[64:67], v[72:87]
    s_waitcnt vmcnt(12)
    ds_read_b64_tr_b16 a[80:81], v14 offset:4096
    ds_read_b64_tr_b16 a[82:83], v14 offset:4608
    ds_read_b64_tr_b16 a[84:85], v15 offset:4096
    ds_read_b64_tr_b16 a[86:87], v15 offset:4608
    s_waitcnt lgkmcnt(5)
    s_add_u32 m0, s57, 2048
    s_mov_b32 s58, 8192
    buffer_load_dwordx4 v10, s[24:27], s58 offen lds
    buffer_load_dwordx4 v11, s[24:27], s58 offen offset:1024 lds
    v_mfma_f32_32x32x16_bf16 v[56:71], a[88:91], a[68:71], v[56:71]
    ds_read_b128 a[76:79], v44 offset:752
    v_mfma_f32_32x32x16_bf16 v[72:87], a[92:95], a[68:71], v[72:87]
    s_waitcnt vmcnt(12)
    ds_read_b64_tr_b16 a[56:57], v14 offset:6144
    ds_read_b64_tr_b16 a[58:59], v14 offset:6656
    ds_read_b64_tr_b16 a[60:61], v15 offset:6144
    ds_read_b64_tr_b16 a[62:63], v15 offset:6656
    s_waitcnt lgkmcnt(5)
    s_add_u32 m0, s57, 4096
    s_mov_b32 s58, 32768
    buffer_load_dwordx4 v10, s[24:27], s58 offen lds
    buffer_load_dwordx4 v11, s[24:27], s58 offen offset:1024 lds
    v_mfma_f32_32x32x16_bf16 v[56:71], a[80:83], a[72:75], v[56:71]
    ds_read_b128 a[64:67], v44 offset:848
    v_mfma_f32_32x32x16_bf16 v[72:87], a[84:87], a[72:75], v[72:87]
    s_waitcnt vmcnt(12)
    ds_read_b64_tr_b16 a[0:1], v14 offset:8192
    ds_read_b64_tr_b16 a[2:3], v14 offset:8704
    ds_read_b64_tr_b16 a[4:5], v15 offset:8192
    ds_read_b64_tr_b16 a[6:7], v15 offset:8704
    s_waitcnt lgkmcnt(5)
    s_add_u32 m0, s57, 6144
    s_mov_b32 s58, 40960
    buffer_load_dwordx4 v10, s[24:27], s58 offen lds
    buffer_load_dwordx4 v11, s[24:27], s58 offen offset:1024 lds
    v_mfma_f32_32x32x16_bf16 v[56:71], a[56:59], a[76:79], v[56:71]
    ds_read_b128 a[68:71], v44 offset:880
    v_mfma_f32_32x32x16_bf16 v[72:87], a[60:63], a[76:79], v[72:87]
    s_waitcnt vmcnt(12)
    ds_read_b64_tr_b16 a[8:9], v14 offset:10240
    ds_read_b64_tr_b16 a[10:11], v14 offset:10752
    ds_read_b64_tr_b16 a[12:13], v15 offset:10240
    ds_read_b64_tr_b16 a[14:15], v15 offset:10752
    s_waitcnt lgkmcnt(5)
    s_add_u32 m0, s57, 8192
    s_mov_b32 s58, 65536
    buffer_load_dwordx4 v10, s[24:27], s58 offen lds
    buffer_load_dwordx4 v11, s[24:27], s58 offen offset:1024 lds
    v_mfma_f32_32x32x16_bf16 v[56:71], a[0:3], a[64:67], v[56:71]
    ds_read_b128 a[72:75], v44 offset:976
    v_mfma_f32_32x32x16_bf16 v[72:87], a[4:7], a[64:67], v[72:87]
    s_waitcnt vmcnt(12)
    ds_read_b64_tr_b16 a[16:17], v14 offset:12288
    ds_read_b64_tr_b16 a[18:19], v14 offset:12800
    ds_read_b64_tr_b16 a[20:21], v15 offset:12288
    ds_read_b64_tr_b16 a[22:23], v15 offset:12800
    s_waitcnt lgkmcnt(5)
    s_add_u32 m0, s57, 10240
    s_mov_b32 s58, 73728
    buffer_load_dwordx4 v10, s[24:27], s58 offen lds
    buffer_load_dwordx4 v11, s[24:27], s58 offen offset:1024 lds
    v_mfma_f32_32x32x16_bf16 v[56:71], a[8:11], a[68:71], v[56:71]
    ds_read_b128 a[76:79], v44 offset:1008
    v_mfma_f32_32x32x16_bf16 v[72:87], a[12:15], a[68:71], v[72:87]
    s_waitcnt vmcnt(12)
    ds_read_b64_tr_b16 a[24:25], v14 offset:14336
    ds_read_b64_tr_b16 a[26:27], v14 offset:14848
    ds_read_b64_tr_b16 a[28:29], v15 offset:14336
    ds_read_b64_tr_b16 a[30:31], v15 offset:14848
    s_waitcnt lgkmcnt(5)
    s_add_u32 m0, s57, 12288
    s_mov_b32 s58, 98304
    buffer_load_dwordx4 v10, s[24:27], s58 offen lds
    buffer_load_dwordx4 v11, s[24:27], s58 offen offset:1024 lds
    v_mfma_f32_32x32x16_bf16 v[56:71], a[16:19], a[72:75], v[56:71]
    v_mfma_f32_32x32x16_bf16 v[72:87], a[20:23], a[72:75], v[72:87]
    s_waitcnt vmcnt(12)
    ds_read_b64_tr_b16 a[32:33], v14
    ds_read_b64_tr_b16 a[34:35], v14 offset:512
    ds_read_b64_tr_b16 a[36:37], v15
    ds_read_b64_tr_b16 a[38:39], v15 offset:512
    s_waitcnt lgkmcnt(4)
    s_add_u32 m0, s57, 14336
    s_mov_b32 s58, 106496
    buffer_load_dwordx4 v10, s[24:27], s58 offen lds
    buffer_load_dwordx4 v11, s[24:27], s58 offen offset:1024 lds
    v_mfma_f32_32x32x16_bf16 v[56:71], a[24:27], a[76:79], v[56:71]
    s_mov_b32 s49, 16896
    s_mov_b32 s50, 93216
    s_mov_b32 s51, 4294857184
    v_mfma_f32_32x32x16_bf16 v[72:87], a[28:31], a[76:79], v[72:87]
    s_barrier
    s_nop 11
    ds_write_b128 v52, v[72:75]
    ds_write_b128 v52, v[76:79] offset:1024
    ds_write_b128 v52, v[80:83] offset:2048
    ds_write_b128 v52, v[84:87] offset:3072
    s_waitcnt lgkmcnt(0)
    s_barrier
    v_pk_mul_f32 v[152:153], v[56:57], v[56:57]
    v_pk_mul_f32 v[154:155], v[58:59], v[58:59]
    v_pk_fma_f32 v[152:153], v[152:153], v[54:55], s[4:5]
    v_pk_fma_f32 v[154:155], v[154:155], v[54:55], s[4:5]
    v_pk_mul_f32 v[152:153], v[56:57], v[152:153]
    v_pk_mul_f32 v[154:155], v[58:59], v[154:155]
    v_exp_f32 v152, v152
    v_exp_f32 v153, v153
    v_exp_f32 v154, v154
    v_exp_f32 v155, v155
    v_pk_add_f32 v[152:153], v[152:153], 1.0 op_sel_hi:[1,0]
    v_pk_add_f32 v[154:155], v[154:155], 1.0 op_sel_hi:[1,0]
    v_rcp_f32 v152, v152
    v_rcp_f32 v153, v153
    v_rcp_f32 v154, v154
    v_rcp_f32 v155, v155
    v_pk_mul_f32 v[56:57], v[56:57], v[152:153]
    v_pk_mul_f32 v[58:59], v[58:59], v[154:155]
    v_cvt_pk_bf16_f32 v128, v56, v57
    v_cvt_pk_bf16_f32 v129, v58, v59
    v_pk_mul_f32 v[152:153], v[60:61], v[60:61]
    v_pk_mul_f32 v[154:155], v[62:63], v[62:63]
    v_pk_fma_f32 v[152:153], v[152:153], v[54:55], s[4:5]
    v_pk_fma_f32 v[154:155], v[154:155], v[54:55], s[4:5]
    v_pk_mul_f32 v[152:153], v[60:61], v[152:153]
    v_pk_mul_f32 v[154:155], v[62:63], v[154:155]
    v_exp_f32 v152, v152
    v_exp_f32 v153, v153
    v_exp_f32 v154, v154
    v_exp_f32 v155, v155
    s_waitcnt vmcnt(12)
    ds_read_b64_tr_b16 a[40:41], v14 offset:2048
    ds_read_b64_tr_b16 a[42:43], v14 offset:2560
    ds_read_b64_tr_b16 a[44:45], v15 offset:2048
    ds_read_b64_tr_b16 a[46:47], v15 offset:2560
    s_waitcnt vmcnt(10)
    ds_read_b64_tr_b16 a[48:49], v14 offset:4096
    ds_read_b64_tr_b16 a[50:51], v14 offset:4608
    ds_read_b64_tr_b16 a[52:53], v15 offset:4096
    ds_read_b64_tr_b16 a[54:55], v15 offset:4608
    v_pk_add_f32 v[152:153], v[152:153], 1.0 op_sel_hi:[1,0]
    v_pk_add_f32 v[154:155], v[154:155], 1.0 op_sel_hi:[1,0]
    v_rcp_f32 v152, v152
    v_rcp_f32 v153, v153
    v_rcp_f32 v154, v154
    v_rcp_f32 v155, v155
    v_pk_mul_f32 v[60:61], v[60:61], v[152:153]
    v_pk_mul_f32 v[62:63], v[62:63], v[154:155]
    v_cvt_pk_bf16_f32 v130, v60, v61
    v_cvt_pk_bf16_f32 v131, v62, v63
    v_pk_mul_f32 v[152:153], v[64:65], v[64:65]
    v_pk_mul_f32 v[154:155], v[66:67], v[66:67]
    v_pk_fma_f32 v[152:153], v[152:153], v[54:55], s[4:5]
    v_pk_fma_f32 v[154:155], v[154:155], v[54:55], s[4:5]
    v_pk_mul_f32 v[152:153], v[64:65], v[152:153]
    v_pk_mul_f32 v[154:155], v[66:67], v[154:155]
    v_exp_f32 v152, v152
    v_exp_f32 v153, v153
    v_exp_f32 v154, v154
    v_exp_f32 v155, v155
    v_pk_add_f32 v[152:153], v[152:153], 1.0 op_sel_hi:[1,0]
    v_pk_add_f32 v[154:155], v[154:155], 1.0 op_sel_hi:[1,0]
    v_rcp_f32 v152, v152
    v_rcp_f32 v153, v153
    v_rcp_f32 v154, v154
    v_rcp_f32 v155, v155
    v_pk_mul_f32 v[64:65], v[64:65], v[152:153]
    v_pk_mul_f32 v[66:67], v[66:67], v[154:155]
    v_cvt_pk_bf16_f32 v132, v64, v65
    v_cvt_pk_bf16_f32 v133, v66, v67
    s_waitcnt vmcnt(8)
    ds_read_b64_tr_b16 a[88:89], v14 offset:6144
    ds_read_b64_tr_b16 a[90:91], v14 offset:6656
    ds_read_b64_tr_b16 a[92:93], v15 offset:6144
    ds_read_b64_tr_b16 a[94:95], v15 offset:6656
    s_waitcnt vmcnt(6)
    ds_read_b64_tr_b16 a[80:81], v14 offset:8192
    ds_read_b64_tr_b16 a[82:83], v14 offset:8704
    ds_read_b64_tr_b16 a[84:85], v15 offset:8192
    ds_read_b64_tr_b16 a[86:87], v15 offset:8704
    v_pk_mul_f32 v[152:153], v[68:69], v[68:69]
    v_pk_mul_f32 v[154:155], v[70:71], v[70:71]
    v_pk_fma_f32 v[152:153], v[152:153], v[54:55], s[4:5]
    v_pk_fma_f32 v[154:155], v[154:155], v[54:55], s[4:5]
    v_pk_mul_f32 v[152:153], v[68:69], v[152:153]
    v_pk_mul_f32 v[154:155], v[70:71], v[154:155]
    v_exp_f32 v152, v152
    v_exp_f32 v153, v153
    v_exp_f32 v154, v154
    v_exp_f32 v155, v155
    v_pk_add_f32 v[152:153], v[152:153], 1.0 op_sel_hi:[1,0]
    v_pk_add_f32 v[154:155], v[154:155], 1.0 op_sel_hi:[1,0]
    v_rcp_f32 v152, v152
    v_rcp_f32 v153, v153
    v_rcp_f32 v154, v154
    v_rcp_f32 v155, v155
    v_pk_mul_f32 v[68:69], v[68:69], v[152:153]
    v_pk_mul_f32 v[70:71], v[70:71], v[154:155]
    v_cvt_pk_bf16_f32 v134, v68, v69
    v_cvt_pk_bf16_f32 v135, v70, v71
    ds_write_b128 v45, v[128:131] offset:36864
    ds_write_b128 v45, v[132:135] offset:36896
    s_waitcnt lgkmcnt(0)
    s_barrier
    ds_read_b128 a[64:67], v44 offset:36864
    ds_read_b128 a[68:71], v44 offset:36896
    s_add_u32 m0, s57, 0
    s_mov_b32 s58, 16384
    buffer_load_dwordx4 v10, s[24:27], s58 offen lds
    buffer_load_dwordx4 v11, s[24:27], s58 offen offset:1024 lds
    s_add_u32 m0, s57, 2048
    s_mov_b32 s58, 24576
    buffer_load_dwordx4 v10, s[24:27], s58 offen lds
    buffer_load_dwordx4 v11, s[24:27], s58 offen offset:1024 lds
    s_add_u32 m0, s57, 4096
    s_mov_b32 s58, 49152
    buffer_load_dwordx4 v10, s[24:27], s58 offen lds
    buffer_load_dwordx4 v11, s[24:27], s58 offen offset:1024 lds
    s_add_u32 m0, s57, 6144
    s_mov_b32 s58, 57344
    buffer_load_dwordx4 v10, s[24:27], s58 offen lds
    buffer_load_dwordx4 v11, s[24:27], s58 offen offset:1024 lds
    s_waitcnt lgkmcnt(1)
    v_mfma_f32_32x32x16_bf16 v[88:103], a[32:35], a[64:67], 0
    ds_read_b128 a[72:75], v44 offset:36992
    s_waitcnt vmcnt(12)
    ds_read_b64_tr_b16 a[56:57], v14 offset:10240
    ds_read_b64_tr_b16 a[58:59], v14 offset:10752
    ds_read_b64_tr_b16 a[60:61], v15 offset:10240
    ds_read_b64_tr_b16 a[62:63], v15 offset:10752
    v_mfma_f32_32x32x16_bf16 v[104:119], a[36:39], a[64:67], 0
    s_waitcnt vmcnt(10)
    ds_read_b64_tr_b16 a[0:1], v14 offset:12288
    ds_read_b64_tr_b16 a[2:3], v14 offset:12800
    ds_read_b64_tr_b16 a[4:5], v15 offset:12288
    ds_read_b64_tr_b16 a[6:7], v15 offset:12800
    s_add_u32 m0, s57, 8192
    s_mov_b32 s58, 81920
    buffer_load_dwordx4 v10, s[24:27], s58 offen lds
    buffer_load_dwordx4 v11, s[24:27], s58 offen offset:1024 lds
    s_waitcnt lgkmcnt(4)
    s_add_u32 m0, s57, 10240
    s_mov_b32 s58, 90112
    buffer_load_dwordx4 v10, s[24:27], s58 offen lds
    buffer_load_dwordx4 v11, s[24:27], s58 offen offset:1024 lds
    v_mfma_f32_32x32x16_bf16 v[88:103], a[40:43], a[68:71], v[88:103]
    ds_read_b128 a[76:79], v44 offset:37024
    v_mfma_f32_32x32x16_bf16 v[104:119], a[44:47], a[68:71], v[104:119]
    v_mfma_f32_32x32x16_bf16 v[88:103], a[48:51], a[72:75], v[88:103]
    ds_read_b128 a[64:67], v44 offset:37120
    s_waitcnt vmcnt(12)
    ds_read_b64_tr_b16 a[8:9], v14 offset:14336
    ds_read_b64_tr_b16 a[10:11], v14 offset:14848
    ds_read_b64_tr_b16 a[12:13], v15 offset:14336
    ds_read_b64_tr_b16 a[14:15], v15 offset:14848
    v_mfma_f32_32x32x16_bf16 v[104:119], a[52:55], a[72:75], v[104:119]
    s_waitcnt lgkmcnt(6)
    s_add_u32 m0, s57, 12288
    s_mov_b32 s58, 114688
    buffer_load_dwordx4 v10, s[24:27], s58 offen lds
    buffer_load_dwordx4 v11, s[24:27], s58 offen offset:1024 lds
    s_waitcnt lgkmcnt(5)
    v_mfma_f32_32x32x16_bf16 v[88:103], a[88:91], a[76:79], v[88:103]
    ds_read_b128 a[68:71], v44 offset:37152
    v_mfma_f32_32x32x16_bf16 v[104:119], a[92:95], a[76:79], v[104:119]
    s_waitcnt lgkmcnt(5)
    v_mfma_f32_32x32x16_bf16 v[88:103], a[80:83], a[64:67], v[88:103]
    ds_read_b128 a[72:75], v44 offset:37248
    v_mfma_f32_32x32x16_bf16 v[104:119], a[84:87], a[64:67], v[104:119]
    s_waitcnt lgkmcnt(1)
    v_mfma_f32_32x32x16_bf16 v[88:103], a[56:59], a[68:71], v[88:103]
    ds_read_b128 a[76:79], v44 offset:37280
    v_mfma_f32_32x32x16_bf16 v[104:119], a[60:63], a[68:71], v[104:119]
    s_waitcnt lgkmcnt(1)
    v_mfma_f32_32x32x16_bf16 v[88:103], a[0:3], a[72:75], v[88:103]
    ds_read_b128 a[64:67], v44 offset:36928
    v_mfma_f32_32x32x16_bf16 v[104:119], a[4:7], a[72:75], v[104:119]
    s_waitcnt vmcnt(12)
    ds_read_b64_tr_b16 a[16:17], v14
    ds_read_b64_tr_b16 a[18:19], v14 offset:512
    ds_read_b64_tr_b16 a[20:21], v15
    ds_read_b64_tr_b16 a[22:23], v15 offset:512
    s_add_u32 m0, s57, 14336
    s_mov_b32 s58, 122880
    buffer_load_dwordx4 v10, s[24:27], s58 offen lds
    buffer_load_dwordx4 v11, s[24:27], s58 offen offset:1024 lds
    s_waitcnt lgkmcnt(5)
    v_mfma_f32_32x32x16_bf16 v[88:103], a[8:11], a[76:79], v[88:103]
    ds_read_b128 a[68:71], v44 offset:36960
    v_mfma_f32_32x32x16_bf16 v[104:119], a[12:15], a[76:79], v[104:119]
    s_waitcnt vmcnt(12)
    ds_read_b64_tr_b16 a[24:25], v14 offset:2048
    ds_read_b64_tr_b16 a[26:27], v14 offset:2560
    ds_read_b64_tr_b16 a[28:29], v15 offset:2048
    ds_read_b64_tr_b16 a[30:31], v15 offset:2560
    s_waitcnt lgkmcnt(7)
    v_mfma_f32_32x32x16_bf16 v[88:103], a[16:19], a[64:67], v[88:103]
    ds_read_b128 a[72:75], v44 offset:37056
    s_waitcnt lgkmcnt(6)
    v_mfma_f32_32x32x16_bf16 v[104:119], a[20:23], a[64:67], v[104:119]
    s_waitcnt vmcnt(10)
    ds_read_b64_tr_b16 a[32:33], v14 offset:4096
    ds_read_b64_tr_b16 a[34:35], v14 offset:4608
    ds_read_b64_tr_b16 a[36:37], v15 offset:4096
    ds_read_b64_tr_b16 a[38:39], v15 offset:4608
    s_waitcnt lgkmcnt(7)
    v_mfma_f32_32x32x16_bf16 v[88:103], a[24:27], a[68:71], v[88:103]
    ds_read_b128 a[76:79], v44 offset:37088
    s_waitcnt lgkmcnt(6)
    v_mfma_f32_32x32x16_bf16 v[104:119], a[28:31], a[68:71], v[104:119]
    s_waitcnt vmcnt(8)
    ds_read_b64_tr_b16 a[40:41], v14 offset:6144
    ds_read_b64_tr_b16 a[42:43], v14 offset:6656
    ds_read_b64_tr_b16 a[44:45], v15 offset:6144
    ds_read_b64_tr_b16 a[46:47], v15 offset:6656
    s_waitcnt lgkmcnt(7)
    v_mfma_f32_32x32x16_bf16 v[88:103], a[32:35], a[72:75], v[88:103]
    ds_read_b128 a[64:67], v44 offset:37184
    s_waitcnt lgkmcnt(6)
    v_mfma_f32_32x32x16_bf16 v[104:119], a[36:39], a[72:75], v[104:119]
    s_waitcnt vmcnt(6)
    ds_read_b64_tr_b16 a[48:49], v14 offset:8192
    ds_read_b64_tr_b16 a[50:51], v14 offset:8704
    ds_read_b64_tr_b16 a[52:53], v15 offset:8192
    ds_read_b64_tr_b16 a[54:55], v15 offset:8704
    s_waitcnt lgkmcnt(7)
    v_mfma_f32_32x32x16_bf16 v[88:103], a[40:43], a[76:79], v[88:103]
    ds_read_b128 a[68:71], v44 offset:37216
    s_waitcnt lgkmcnt(6)
    v_mfma_f32_32x32x16_bf16 v[104:119], a[44:47], a[76:79], v[104:119]
    s_waitcnt vmcnt(4)
    ds_read_b64_tr_b16 a[88:89], v14 offset:10240
    ds_read_b64_tr_b16 a[90:91], v14 offset:10752
    ds_read_b64_tr_b16 a[92:93], v15 offset:10240
    ds_read_b64_tr_b16 a[94:95], v15 offset:10752
    s_waitcnt lgkmcnt(7)
    v_mfma_f32_32x32x16_bf16 v[88:103], a[48:51], a[64:67], v[88:103]
    ds_read_b128 a[72:75], v44 offset:37312
    s_waitcnt lgkmcnt(6)
    v_mfma_f32_32x32x16_bf16 v[104:119], a[52:55], a[64:67], v[104:119]
    s_waitcnt vmcnt(2)
    ds_read_b64_tr_b16 a[80:81], v14 offset:12288
    ds_read_b64_tr_b16 a[82:83], v14 offset:12800
    ds_read_b64_tr_b16 a[84:85], v15 offset:12288
    ds_read_b64_tr_b16 a[86:87], v15 offset:12800
    s_waitcnt lgkmcnt(7)
    v_mfma_f32_32x32x16_bf16 v[88:103], a[88:91], a[68:71], v[88:103]
    ds_read_b128 a[76:79], v44 offset:37344
    s_waitcnt lgkmcnt(6)
    v_mfma_f32_32x32x16_bf16 v[104:119], a[92:95], a[68:71], v[104:119]
    s_waitcnt vmcnt(0)
    ds_read_b64_tr_b16 a[56:57], v14 offset:14336
    ds_read_b64_tr_b16 a[58:59], v14 offset:14848
    ds_read_b64_tr_b16 a[60:61], v15 offset:14336
    ds_read_b64_tr_b16 a[62:63], v15 offset:14848
    s_waitcnt lgkmcnt(7)
    v_mfma_f32_32x32x16_bf16 v[88:103], a[80:83], a[72:75], v[88:103]
    s_waitcnt lgkmcnt(5)
    v_mfma_f32_32x32x16_bf16 v[104:119], a[84:87], a[72:75], v[104:119]
    s_waitcnt lgkmcnt(2)
    v_mfma_f32_32x32x16_bf16 v[88:103], a[56:59], a[76:79], v[88:103]
    s_waitcnt lgkmcnt(0)
    v_mfma_f32_32x32x16_bf16 v[104:119], a[60:63], a[76:79], v[104:119]
    s_nop 9
    v_pk_mul_f32 v[128:129], v[88:89], s[6:7]
    v_pk_mul_f32 v[130:131], v[90:91], s[6:7]
    v_pk_mul_f32 v[132:133], v[92:93], s[6:7]
    v_pk_mul_f32 v[134:135], v[94:95], s[6:7]
    v_pk_mul_f32 v[136:137], v[96:97], s[6:7]
    v_pk_mul_f32 v[138:139], v[98:99], s[6:7]
    v_pk_mul_f32 v[140:141], v[100:101], s[6:7]
    v_pk_mul_f32 v[142:143], v[102:103], s[6:7]
    v_pk_mul_f32 v[144:145], v[104:105], s[6:7]
    v_pk_mul_f32 v[146:147], v[106:107], s[6:7]
    v_pk_mul_f32 v[148:149], v[108:109], s[6:7]
    v_pk_mul_f32 v[150:151], v[110:111], s[6:7]
    v_pk_mul_f32 v[152:153], v[112:113], s[6:7]
    v_pk_mul_f32 v[154:155], v[114:115], s[6:7]
    v_pk_mul_f32 v[156:157], v[116:117], s[6:7]
    v_pk_mul_f32 v[158:159], v[118:119], s[6:7]
    v_exp_f32 v56, v128
    v_exp_f32 v57, v129
    v_max3_f32 v48, |v128|, |v129|, v48
    v_exp_f32 v58, v130
    v_exp_f32 v59, v131
    v_max3_f32 v48, |v130|, |v131|, v48
    v_exp_f32 v60, v132
    v_exp_f32 v61, v133
    v_max3_f32 v48, |v132|, |v133|, v48
    v_exp_f32 v62, v134
    v_exp_f32 v63, v135
    v_max3_f32 v48, |v134|, |v135|, v48
    v_exp_f32 v64, v136
    v_exp_f32 v65, v137
    v_max3_f32 v48, |v136|, |v137|, v48
    v_exp_f32 v66, v138
    v_exp_f32 v67, v139
    v_max3_f32 v48, |v138|, |v139|, v48
    v_exp_f32 v68, v140
    v_exp_f32 v69, v141
    v_max3_f32 v48, |v140|, |v141|, v48
    v_exp_f32 v70, v142
    v_exp_f32 v71, v143
    v_max3_f32 v48, |v142|, |v143|, v48
    v_exp_f32 v72, v144
    v_exp_f32 v73, v145
    v_max3_f32 v48, |v144|, |v145|, v48
    v_exp_f32 v74, v146
    v_exp_f32 v75, v147
    v_max3_f32 v48, |v146|, |v147|, v48
    v_exp_f32 v76, v148
    v_exp_f32 v77, v149
    v_max3_f32 v48, |v148|, |v149|, v48
    v_exp_f32 v78, v150
    v_exp_f32 v79, v151
    v_max3_f32 v48, |v150|, |v151|, v48
    v_exp_f32 v80, v152
    v_exp_f32 v81, v153
    v_max3_f32 v48, |v152|, |v153|, v48
    v_exp_f32 v82, v154
    v_exp_f32 v83, v155
    v_max3_f32 v48, |v154|, |v155|, v48
    v_exp_f32 v84, v156
    v_exp_f32 v85, v157
    v_max3_f32 v48, |v156|, |v157|, v48
    v_exp_f32 v86, v158
    v_exp_f32 v87, v159
    v_max3_f32 v48, |v158|, |v159|, v48
    ds_write_b128 v46, v[56:59]
    ds_write_b128 v46, v[60:63] offset:512
    ds_write_b128 v46, v[64:67] offset:32
    ds_write_b128 v46, v[68:71] offset:544
    ds_write_b128 v46, v[72:75] offset:64
    ds_write_b128 v46, v[76:79] offset:576
    ds_write_b128 v46, v[80:83] offset:96
    ds_write_b128 v46, v[84:87] offset:608
    s_mov_b32 s67, 0x42fa0000
    v_cmp_lt_f32 vcc, s67, v48
    s_nop 1
    s_cmp_lg_u64 vcc, 0
    s_cselect_b32 s64, 1, 0
    s_lshl_b32 s65, s56, 2
    s_add_u32 s65, s65, 143360
    v_mov_b32 v2, s64
    v_mov_b32 v3, s65
    ds_write_b32 v3, v2
    s_waitcnt lgkmcnt(0)
    s_barrier
    v_mov_b32 v3, 143360
    ds_read_b128 v[4:7], v3
    s_waitcnt lgkmcnt(0)
    v_or3_b32 v2, v4, v5, v6
    v_or_b32 v2, v2, v7
    ds_read_b128 v[4:7], v3 offset:16
    s_waitcnt lgkmcnt(0)
    v_or3_b32 v2, v4, v5, v2
    v_or3_b32 v2, v6, v7, v2
    s_nop 0
    v_readfirstlane_b32 s64, v2
    s_nop 4
    s_cmp_lg_u32 s64, 0
    s_cbranch_scc1 L_c_slow
    ds_read_b128 v[56:59], v51
    ds_read_b128 v[60:63], v51 offset:512
    ds_read_b128 v[64:67], v51 offset:1024
    ds_read_b128 v[68:71], v51 offset:1536
    ds_read_b128 v[72:75], v51 offset:2048
    ds_read_b128 v[76:79], v51 offset:2560
    ds_read_b128 v[80:83], v51 offset:3072
    ds_read_b128 v[84:87], v51 offset:3584
    ds_read_b128 v[88:91], v50
    ds_read_b128 v[92:95], v50 offset:512
    v_add_u32 v50, 4160, v50
    s_waitcnt lgkmcnt(1)
    v_pk_fma_f32 v[96:97], v[88:89], v[56:57], -0.5 op_sel_hi:[1,1,0]
    v_pk_fma_f32 v[98:99], v[90:91], v[58:59], -0.5 op_sel_hi:[1,1,0]
    s_waitcnt lgkmcnt(0)
    v_pk_fma_f32 v[100:101], v[92:93], v[60:61], -0.5 op_sel_hi:[1,1,0]
    v_pk_fma_f32 v[102:103], v[94:95], v[62:63], -0.5 op_sel_hi:[1,1,0]
    v_rcp_f32 v96, v96
    v_rcp_f32 v97, v97
    v_rcp_f32 v98, v98
    v_rcp_f32 v99, v99
    v_pk_add_f32 v[96:97], v[96:97], 1.0 op_sel_hi:[1,0]
    v_pk_add_f32 v[98:99], v[98:99], 1.0 op_sel_hi:[1,0]
    v_cvt_pk_bf16_f32 v104, v96, v97
    v_cvt_pk_bf16_f32 v105, v98, v99
    v_rcp_f32 v100, v100
    v_rcp_f32 v101, v101
    v_rcp_f32 v102, v102
    v_rcp_f32 v103, v103
    v_pk_add_f32 v[100:101], v[100:101], 1.0 op_sel_hi:[1,0]
    v_pk_add_f32 v[102:103], v[102:103], 1.0 op_sel_hi:[1,0]
    v_cvt_pk_bf16_f32 v106, v100, v101
    v_cvt_pk_bf16_f32 v107, v102, v103
    ds_write_b128 v18, v[104:107]
    v_pk_fma_f32 v[96:97], v[88:89], v[64:65], -0.5 op_sel_hi:[1,1,0]
    v_pk_fma_f32 v[98:99], v[90:91], v[66:67], -0.5 op_sel_hi:[1,1,0]
    v_pk_fma_f32 v[100:101], v[92:93], v[68:69], -0.5 op_sel_hi:[1,1,0]
    v_pk_fma_f32 v[102:103], v[94:95], v[70:71], -0.5 op_sel_hi:[1,1,0]
    ds_read_b128 v[88:91], v50
    ds_read_b128 v[92:95], v50 offset:512
    v_add_u32 v50, 4160, v50
    v_rcp_f32 v96, v96
    v_rcp_f32 v97, v97
    v_rcp_f32 v98, v98
    v_rcp_f32 v99, v99
    v_pk_add_f32 v[96:97], v[96:97], 1.0 op_sel_hi:[1,0]
    v_pk_add_f32 v[98:99], v[98:99], 1.0 op_sel_hi:[1,0]
    v_cvt_pk_bf16_f32 v104, v96, v97
    v_cvt_pk_bf16_f32 v105, v98, v99
    v_rcp_f32 v100, v100
    v_rcp_f32 v101, v101
    v_rcp_f32 v102, v102
    v_rcp_f32 v103, v103
    v_pk_add_f32 v[100:101], v[100:101], 1.0 op_sel_hi:[1,0]
    v_pk_add_f32 v[102:103], v[102:103], 1.0 op_sel_hi:[1,0]
    v_cvt_pk_bf16_f32 v106, v100, v101
    v_cvt_pk_bf16_f32 v107, v102, v103
    ds_write_b128 v18, v[104:107] offset:528
    s_waitcnt lgkmcnt(2)
    v_pk_fma_f32 v[96:97], v[88:89], v[56:57], -0.5 op_sel_hi:[1,1,0]
    v_pk_fma_f32 v[98:99], v[90:91], v[58:59], -0.5 op_sel_hi:[1,1,0]
    s_waitcnt lgkmcnt(1)
    v_pk_fma_f32 v[100:101], v[92:93], v[60:61], -0.5 op_sel_hi:[1,1,0]
    v_pk_fma_f32 v[102:103], v[94:95], v[62:63], -0.5 op_sel_hi:[1,1,0]
    v_rcp_f32 v96, v96
    v_rcp_f32 v97, v97
    v_rcp_f32 v98, v98
    v_rcp_f32 v99, v99
    v_pk_add_f32 v[96:97], v[96:97], 1.0 op_sel_hi:[1,0]
    v_pk_add_f32 v[98:99], v[98:99], 1.0 op_sel_hi:[1,0]
    v_cvt_pk_bf16_f32 v104, v96, v97
    v_cvt_pk_bf16_f32 v105, v98, v99
    v_rcp_f32 v100, v100
    v_rcp_f32 v101, v101
    v_rcp_f32 v102, v102
    v_rcp_f32 v103, v103
    v_pk_add_f32 v[100:101], v[100:101], 1.0 op_sel_hi:[1,0]
    v_pk_add_f32 v[102:103], v[102:103], 1.0 op_sel_hi:[1,0]
    v_cvt_pk_bf16_f32 v106, v100, v101
    v_cvt_pk_bf16_f32 v107, v102, v103
    ds_write_b128 v19, v[104:107]
    v_pk_fma_f32 v[96:97], v[88:89], v[64:65], -0.5 op_sel_hi:[1,1,0]
    v_pk_fma_f32 v[98:99], v[90:91], v[66:67], -0.5 op_sel_hi:[1,1,0]
    v_pk_fma_f32 v[100:101], v[92:93], v[68:69], -0.5 op_sel_hi:[1,1,0]
    v_pk_fma_f32 v[102:103], v[94:95], v[70:71], -0.5 op_sel_hi:[1,1,0]
    ds_read_b128 v[88:91], v50
    ds_read_b128 v[92:95], v50 offset:512
    v_add_u32 v50, 4160, v50
    v_rcp_f32 v96, v96
    v_rcp_f32 v97, v97
    v_rcp_f32 v98, v98
    v_rcp_f32 v99, v99
    v_pk_add_f32 v[96:97], v[96:97], 1.0 op_sel_hi:[1,0]
    v_pk_add_f32 v[98:99], v[98:99], 1.0 op_sel_hi:[1,0]
    v_cvt_pk_bf16_f32 v104, v96, v97
    v_cvt_pk_bf16_f32 v105, v98, v99
    v_rcp_f32 v100, v100
    v_rcp_f32 v101, v101
    v_rcp_f32 v102, v102
    v_rcp_f32 v103, v103
    v_pk_add_f32 v[100:101], v[100:101], 1.0 op_sel_hi:[1,0]
    v_pk_add_f32 v[102:103], v[102:103], 1.0 op_sel_hi:[1,0]
    v_cvt_pk_bf16_f32 v106, v100, v101
    v_cvt_pk_bf16_f32 v107, v102, v103
    ds_write_b128 v19, v[104:107] offset:528
    s_mov_b32 s68, 6
    s_waitcnt lgkmcnt(0)
    s_barrier
L_c_loop:
    v_fma_f32 v96, v88, v56, -0.5
    v_fma_f32 v97, v89, v57, -0.5
    v_fma_f32 v98, v90, v58, -0.5
    v_fma_f32 v99, v91, v59, -0.5
    v_fma_f32 v100, v92, v60, -0.5
    v_fma_f32 v101, v93, v61, -0.5
    v_fma_f32 v102, v94, v62, -0.5
    v_fma_f32 v103, v95, v63, -0.5
    v_rcp_f32 v96, v96
    v_rcp_f32 v97, v97
    v_rcp_f32 v98, v98
    v_rcp_f32 v99, v99
    v_add_f32 v96, 1.0, v96
    v_add_f32 v97, 1.0, v97
    v_add_f32 v98, 1.0, v98
    v_add_f32 v99, 1.0, v99
    v_cvt_pk_bf16_f32 v104, v96, v97
    v_cvt_pk_bf16_f32 v105, v98, v99
    v_rcp_f32 v100, v100
    v_rcp_f32 v101, v101
    v_rcp_f32 v102, v102
    v_rcp_f32 v103, v103
    v_add_f32 v100, 1.0, v100
    v_add_f32 v101, 1.0, v101
    v_add_f32 v102, 1.0, v102
    v_add_f32 v103, 1.0, v103
    v_cvt_pk_bf16_f32 v106, v100, v101
    v_cvt_pk_bf16_f32 v107, v102, v103
    ds_write_b128 v20, v[104:107]
    v_fma_f32 v96, v88, v64, -0.5
    v_fma_f32 v97, v89, v65, -0.5
    v_fma_f32 v98, v90, v66, -0.5
    v_fma_f32 v99, v91, v67, -0.5
    v_fma_f32 v100, v92, v68, -0.5
    v_fma_f32 v101, v93, v69, -0.5
    v_fma_f32 v102, v94, v70, -0.5
    v_fma_f32 v103, v95, v71, -0.5
    v_rcp_f32 v96, v96
    v_rcp_f32 v97, v97
    v_rcp_f32 v98, v98
    v_rcp_f32 v99, v99
    v_add_f32 v96, 1.0, v96
    v_add_f32 v97, 1.0, v97
    v_add_f32 v98, 1.0, v98
    v_add_f32 v99, 1.0, v99
    v_cvt_pk_bf16_f32 v104, v96, v97
    v_cvt_pk_bf16_f32 v105, v98, v99
    v_rcp_f32 v100, v100
    v_rcp_f32 v101, v101
    v_rcp_f32 v102, v102
    v_rcp_f32 v103, v103
    v_add_f32 v100, 1.0, v100
    v_add_f32 v101, 1.0, v101
    v_add_f32 v102, 1.0, v102
    v_add_f32 v103, 1.0, v103
    v_cvt_pk_bf16_f32 v106, v100, v101
    v_cvt_pk_bf16_f32 v107, v102, v103
    ds_write_b128 v20, v[104:107] offset:528
    v_fma_f32 v96, v88, v72, -0.5
    v_fma_f32 v97, v89, v73, -0.5
    v_fma_f32 v98, v90, v74, -0.5
    v_fma_f32 v99, v91, v75, -0.5
    v_fma_f32 v100, v92, v76, -0.5
    v_fma_f32 v101, v93, v77, -0.5
    v_fma_f32 v102, v94, v78, -0.5
    v_fma_f32 v103, v95, v79, -0.5
    v_rcp_f32 v96, v96
    v_rcp_f32 v97, v97
    v_rcp_f32 v98, v98
    v_rcp_f32 v99, v99
    v_add_f32 v96, 1.0, v96
    v_add_f32 v97, 1.0, v97
    v_add_f32 v98, 1.0, v98
    v_add_f32 v99, 1.0, v99
    v_cvt_pk_bf16_f32 v104, v96, v97
    v_cvt_pk_bf16_f32 v105, v98, v99
    v_rcp_f32 v100, v100
    v_rcp_f32 v101, v101
    v_rcp_f32 v102, v102
    v_rcp_f32 v103, v103
    v_add_f32 v100, 1.0, v100
    v_add_f32 v101, 1.0, v101
    v_add_f32 v102, 1.0, v102
    v_add_f32 v103, 1.0, v103
    v_cvt_pk_bf16_f32 v106, v100, v101
    v_cvt_pk_bf16_f32 v107, v102, v103
    ds_write_b128 v20, v[104:107] offset:1056
    v_fma_f32 v96, v88, v80, -0.5
    v_fma_f32 v97, v89, v81, -0.5
    v_fma_f32 v98, v90, v82, -0.5
    v_fma_f32 v99, v91, v83, -0.5
    v_fma_f32 v100, v92, v84, -0.5
    v_fma_f32 v101, v93, v85, -0.5
    v_fma_f32 v102, v94, v86, -0.5
    v_fma_f32 v103, v95, v87, -0.5
    ds_read_b128 v[88:91], v50
    ds_read_b128 v[92:95], v50 offset:512
    v_add_u32 v50, 4160, v50
    v_rcp_f32 v96, v96
    v_rcp_f32 v97, v97
    v_rcp_f32 v98, v98
    v_rcp_f32 v99, v99
    v_add_f32 v96, 1.0, v96
    v_add_f32 v97, 1.0, v97
    v_add_f32 v98, 1.0, v98
    v_add_f32 v99, 1.0, v99
    v_cvt_pk_bf16_f32 v104, v96, v97
    v_cvt_pk_bf16_f32 v105, v98, v99
    v_rcp_f32 v100, v100
    v_rcp_f32 v101, v101
    v_rcp_f32 v102, v102
    v_rcp_f32 v103, v103
    v_add_f32 v100, 1.0, v100
    v_add_f32 v101, 1.0, v101
    v_add_f32 v102, 1.0, v102
    v_add_f32 v103, 1.0, v103
    v_cvt_pk_bf16_f32 v106, v100, v101
    v_cvt_pk_bf16_f32 v107, v102, v103
    ds_write_b128 v20, v[104:107] offset:1584
    v_add_u32 v20, s51, v20
    s_mov_b32 s66, s49
    s_mov_b32 s49, s50
    s_mov_b32 s50, s51
    s_mov_b32 s51, s66
    s_sub_u32 s68, s68, 1
    s_cmp_lg_u32 s68, 0
    s_waitcnt lgkmcnt(0)
    s_barrier
    s_cbranch_scc1 L_c_loop
    s_endpgm
L_h_setup2:
    s_setprio 0
    s_sub_u32 s65, s2, 250
    s_cmp_ge_u32 s2, 250
    s_cselect_b32 s59, s65, s59
    s_load_dwordx2 s[40:41], s[0:1], 64
    s_load_dwordx2 s[52:53], s[0:1], 72
    s_waitcnt lgkmcnt(0)
    s_and_b32 s41, s41, 0xffff
    s_mov_b32 s42, 256
    s_mov_b32 s43, 0x20000
    s_and_b32 s53, s53, 0xffff
    s_mov_b32 s54, 1064960
    s_mov_b32 s55, 0x20000
    v_lshrrev_b32 v2, 4, v1
    v_bfe_u32 v3, v1, 2, 2
    v_and_b32 v4, 3, v1
    v_and_b32 v5, 1, v2
    v_lshl_or_b32 v4, v5, 2, v4
    v_lshrrev_b32 v5, 1, v2
    v_lshlrev_b32 v5, 10, v5
    v_lshl_add_u32 v5, v3, 7, v5
    v_add_u32 v5, s57, v5
    v_lshrrev_b32 v3, 1, v3
    v_and_b32 v8, 1, v4
    v_bfe_u32 v9, v4, 1, 1
    v_lshl_or_b32 v8, v8, 1, v9
    v_and_or_b32 v6, v4, 4, v8
    v_lshlrev_b32 v6, 3, v6
    v_lshl_or_b32 v6, v3, 6, v6
    v_add_u32 v14, v5, v6
    v_xor_b32 v6, 64, v6
    v_add_u32 v15, v5, v6
    v_and_b32 v2, 15, v1
    v_lshrrev_b32 v3, 4, v1
    v_xor_b32 v4, v2, v3
    v_and_b32 v4, 1, v4
    v_lshrrev_b32 v5, 1, v2
    s_lshl_b32 s65, s59, 3
    v_add_u32 v5, s65, v5
    v_lshlrev_b32 v5, 9, v5
    v_lshrrev_b32 v6, 1, v3
    v_lshl_add_u32 v5, v6, 4, v5
    v_lshl_or_b32 v39, v4, 31, v5
    v_and_b32 v4, 1, v2
    v_lshl_or_b32 v4, v4, 2, v3
    v_and_b32 v8, 1, v4
    v_bfe_u32 v9, v4, 1, 1
    v_lshl_or_b32 v8, v8, 1, v9
    v_and_or_b32 v6, v4, 4, v8
    v_lshrrev_b32 v5, 1, v2
    v_lshlrev_b32 v5, 10, v5
    v_and_b32 v7, 1, v6
    v_lshl_add_u32 v5, v7, 9, v5
    v_lshrrev_b32 v7, 1, v6
    v_lshl_add_u32 v5, v7, 4, v5
    v_add_u32 v5, s69, v5
    v_add_u32 v25, 135168, v5
    v_lshlrev_b32 v5, 4, v1
    v_add_u32 v24, s57, v5
    v_mov_b32 v23, 0
    s_lshl_b32 s60, s59, 2
    s_add_u32 s60, s60, s56
    s_lshl_b32 s60, s60, 11
    s_add_u32 s60, s60, 1048576
    s_lshl_b32 s61, s59, 2
    v_lshrrev_b32 v2, 3, v1
    v_lshlrev_b32 v2, 9, v2
    v_add_u32 v2, s69, v2
    v_and_b32 v3, 7, v1
    v_lshrrev_b32 v4, 3, v1
    v_and_b32 v4, 2, v4
    v_xor_b32 v4, v3, v4
    v_lshl_add_u32 v12, v4, 4, v2
    v_add_u32 v13, 3072, v12
    v_lshrrev_b32 v2, 4, v1
    v_bfe_u32 v3, v1, 2, 2
    v_and_b32 v4, 3, v1
    v_and_b32 v5, 1, v2
    v_lshl_or_b32 v4, v5, 2, v4
    v_lshrrev_b32 v5, 1, v2
    v_lshlrev_b32 v5, 10, v5
    v_lshl_add_u32 v5, v3, 7, v5
    v_add_u32 v5, s57, v5
    v_lshrrev_b32 v3, 1, v3
    v_and_b32 v6, 1, v4
    v_lshlrev_b32 v6, 6, v6
    v_lshrrev_b32 v7, 1, v4
    v_lshl_or_b32 v6, v7, 3, v6
    v_lshl_or_b32 v6, v3, 5, v6
    v_add_u32 v16, v5, v6
    v_xor_b32 v6, 32, v6
    v_add_u32 v17, v5, v6
    v_and_b32 v2, 31, v1
    v_lshrrev_b32 v3, 5, v1
    s_mul_i32 s65, s56, 1040
    v_lshlrev_b32 v4, 4, v2
    v_add_u32 v26, s65, v4
    v_lshl_add_u32 v5, v3, 12, v4
    v_add_u32 v27, 137216, v5
    s_mul_i32 s65, s56, 4224
    v_mul_u32_u24 v5, 2112, v3
    v_add3_u32 v5, v5, v4, s65
    v_add_u32 v33, 34336, v5
    v_add_u32 v34, 51232, v5
    v_add_u32 v35, 144448, v5
    v_mul_u32_u24 v4, 528, v2
    v_lshl_add_u32 v4, v3, 4, v4
    v_add_u32 v30, 33280, v4
    v_add_u32 v31, 50176, v4
    s_lshl_b32 s66, s56, 14
    s_add_u32 s66, s66, 69632
    v_mul_u32_u24 v4, 144, v2
    v_lshl_add_u32 v4, v3, 6, v4
    v_add3_u32 v36, v4, s66, 0
    v_lshrrev_b32 v4, 3, v1
    v_and_b32 v5, 7, v1
    v_lshlrev_b32 v5, 4, v5
    v_mul_u32_u24 v6, 144, v4
    v_add3_u32 v28, v6, v5, s66
    v_lshl_add_u32 v6, v4, 9, v5
    v_add_u32 v29, s69, v6
    v_and_b32 v2, 31, v1
    v_lshrrev_b32 v3, 5, v1
    v_mul_u32_u24 v4, 528, v2
    v_lshl_add_u32 v4, v3, 4, v4
    v_add_u32 v37, s69, v4
    v_and_b32 v4, 1, v2
    v_cmp_eq_u32 vcc, 1, v4
    v_mov_b32 v5, 1
    s_nop 0
    v_cndmask_b32 v5, 37, v5, vcc
    v_lshrrev_b32 v4, 1, v2
    v_add_u32 v4, v4, v5
    v_mul_u32_u24 v4, 528, v4
    v_lshl_add_u32 v4, v3, 4, v4
    v_add_u32 v32, s69, v4
    v_mov_b32 v100, 0xbdd2d3e8
    v_mov_b32 v101, 0xbdd2d3e8
    s_lshl_b32 s65, s56, 13
    s_add_u32 s65, s65, 36864
    v_lshlrev_b32 v5, 4, v1
    v_add_u32 v22, s65, v5
    s_cmp_ge_u32 s2, 250
    s_cbranch_scc1 L_ge
    s_waitcnt vmcnt(0)
    s_barrier
    v_lshlrev_b32 v38, 6, v1
    s_lshl_b32 s66, s48, 2
    s_add_u32 s66, s66, s56
    s_lshl_b32 s66, s66, 12
    s_and_b32 s66, s66, 131071
    buffer_load_dword v104, v38, s[32:35], s66 offen
    buffer_load_dword v104, v38, s[24:27], s66 offen
    s_lshl_b32 s66, s48, 2
    s_add_u32 s66, s66, s56
    s_lshl_b32 s66, s66, 12
    s_and_b32 s66, s66, 524287
    buffer_load_dword v104, v38, s[16:19], s66 offen
    s_add_u32 m0, s57, 0
    s_mov_b32 s58, 0
    buffer_load_dwordx4 v12, s[32:35], s58 offen lds
    buffer_load_dwordx4 v13, s[32:35], s58 offen offset:1024 lds
    s_add_u32 m0, s57, 2048
    s_mov_b32 s58, 8192
    buffer_load_dwordx4 v12, s[32:35], s58 offen lds
    buffer_load_dwordx4 v13, s[32:35], s58 offen offset:1024 lds
    s_waitcnt vmcnt(2)
    ds_read_b64_tr_b16 a[0:1], v16
    ds_read_b64_tr_b16 a[2:3], v16 offset:512
    ds_read_b64_tr_b16 a[4:5], v17
    ds_read_b64_tr_b16 a[6:7], v17 offset:512
    s_waitcnt lgkmcnt(0)
    s_add_u32 m0, s57, 0
    s_mov_b32 s58, 16384
    buffer_load_dwordx4 v12, s[32:35], s58 offen lds
    buffer_load_dwordx4 v13, s[32:35], s58 offen offset:1024 lds
    s_waitcnt vmcnt(2)
    ds_read_b64_tr_b16 a[8:9], v16 offset:2048
    ds_read_b64_tr_b16 a[10:11], v16 offset:2560
    ds_read_b64_tr_b16 a[12:13], v17 offset:2048
    ds_read_b64_tr_b16 a[14:15], v17 offset:2560
    s_waitcnt lgkmcnt(0)
    s_add_u32 m0, s57, 2048
    s_mov_b32 s58, 24576
    buffer_load_dwordx4 v12, s[32:35], s58 offen lds
    buffer_load_dwordx4 v13, s[32:35], s58 offen offset:1024 lds
    s_waitcnt vmcnt(2)
    ds_read_b64_tr_b16 a[16:17], v16
    ds_read_b64_tr_b16 a[18:19], v16 offset:512
    ds_read_b64_tr_b16 a[20:21], v17
    ds_read_b64_tr_b16 a[22:23], v17 offset:512
    s_waitcnt lgkmcnt(0)
    s_add_u32 m0, s57, 0
    s_mov_b32 s58, 32768
    buffer_load_dwordx4 v12, s[32:35], s58 offen lds
    buffer_load_dwordx4 v13, s[32:35], s58 offen offset:1024 lds
    s_waitcnt vmcnt(2)
    ds_read_b64_tr_b16 a[24:25], v16 offset:2048
    ds_read_b64_tr_b16 a[26:27], v16 offset:2560
    ds_read_b64_tr_b16 a[28:29], v17 offset:2048
    ds_read_b64_tr_b16 a[30:31], v17 offset:2560
    s_waitcnt lgkmcnt(0)
    s_add_u32 m0, s57, 2048
    s_mov_b32 s58, 40960
    buffer_load_dwordx4 v12, s[32:35], s58 offen lds
    buffer_load_dwordx4 v13, s[32:35], s58 offen offset:1024 lds
    s_waitcnt vmcnt(2)
    ds_read_b64_tr_b16 a[32:33], v16
    ds_read_b64_tr_b16 a[34:35], v16 offset:512
    ds_read_b64_tr_b16 a[36:37], v17
    ds_read_b64_tr_b16 a[38:39], v17 offset:512
    s_waitcnt lgkmcnt(0)
    s_add_u32 m0, s57, 0
    s_mov_b32 s58, 49152
    buffer_load_dwordx4 v12, s[32:35], s58 offen lds
    buffer_load_dwordx4 v13, s[32:35], s58 offen offset:1024 lds
    s_waitcnt vmcnt(2)
    ds_read_b64_tr_b16 a[40:41], v16 offset:2048
    ds_read_b64_tr_b16 a[42:43], v16 offset:2560
    ds_read_b64_tr_b16 a[44:45], v17 offset:2048
    ds_read_b64_tr_b16 a[46:47], v17 offset:2560
    s_waitcnt lgkmcnt(0)
    s_add_u32 m0, s57, 2048
    s_mov_b32 s58, 57344
    buffer_load_dwordx4 v12, s[32:35], s58 offen lds
    buffer_load_dwordx4 v13, s[32:35], s58 offen offset:1024 lds
    s_waitcnt vmcnt(2)
    ds_read_b64_tr_b16 a[48:49], v16
    ds_read_b64_tr_b16 a[50:51], v16 offset:512
    ds_read_b64_tr_b16 a[52:53], v17
    ds_read_b64_tr_b16 a[54:55], v17 offset:512
    s_waitcnt lgkmcnt(0)
    s_add_u32 m0, s57, 0
    s_mov_b32 s58, 65536
    buffer_load_dwordx4 v12, s[32:35], s58 offen lds
    buffer_load_dwordx4 v13, s[32:35], s58 offen offset:1024 lds
    s_waitcnt vmcnt(2)
    ds_read_b64_tr_b16 a[56:57], v16 offset:2048
    ds_read_b64_tr_b16 a[58:59], v16 offset:2560
    ds_read_b64_tr_b16 a[60:61], v17 offset:2048
    ds_read_b64_tr_b16 a[62:63], v17 offset:2560
    s_waitcnt lgkmcnt(0)
    s_add_u32 m0, s57, 2048
    s_mov_b32 s58, 73728
    buffer_load_dwordx4 v12, s[32:35], s58 offen lds
    buffer_load_dwordx4 v13, s[32:35], s58 offen offset:1024 lds
    s_waitcnt vmcnt(2)
    ds_read_b64_tr_b16 a[64:65], v16
    ds_read_b64_tr_b16 a[66:67], v16 offset:512
    ds_read_b64_tr_b16 a[68:69], v17
    ds_read_b64_tr_b16 a[70:71], v17 offset:512
    s_waitcnt lgkmcnt(0)
    s_add_u32 m0, s57, 0
    s_mov_b32 s58, 81920
    buffer_load_dwordx4 v12, s[32:35], s58 offen lds
    buffer_load_dwordx4 v13, s[32:35], s58 offen offset:1024 lds
    s_waitcnt vmcnt(2)
    ds_read_b64_tr_b16 a[72:73], v16 offset:2048
    ds_read_b64_tr_b16 a[74:75], v16 offset:2560
    ds_read_b64_tr_b16 a[76:77], v17 offset:2048
    ds_read_b64_tr_b16 a[78:79], v17 offset:2560
    s_waitcnt lgkmcnt(0)
    s_add_u32 m0, s57, 2048
    s_mov_b32 s58, 90112
    buffer_load_dwordx4 v12, s[32:35], s58 offen lds
    buffer_load_dwordx4 v13, s[32:35], s58 offen offset:1024 lds
    s_waitcnt vmcnt(2)
    ds_read_b64_tr_b16 a[80:81], v16
    ds_read_b64_tr_b16 a[82:83], v16 offset:512
    ds_read_b64_tr_b16 a[84:85], v17
    ds_read_b64_tr_b16 a[86:87], v17 offset:512
    s_waitcnt vmcnt(0)
    ds_read_b64_tr_b16 a[88:89], v16 offset:2048
    ds_read_b64_tr_b16 a[90:91], v16 offset:2560
    ds_read_b64_tr_b16 a[92:93], v17 offset:2048
    ds_read_b64_tr_b16 a[94:95], v17 offset:2560
    s_barrier
    s_barrier
    ds_read_b128 v[40:43], v22
    ds_read_b128 v[44:47], v22 offset:1024
    ds_read_b128 v[48:51], v22 offset:2048
    ds_read_b128 v[52:55], v22 offset:3072
    ds_read_b128 v[56:59], v22 offset:4096
    ds_read_b128 v[60:63], v22 offset:5120
    ds_read_b128 v[64:67], v22 offset:6144
    ds_read_b128 v[68:71], v22 offset:7168
    s_waitcnt lgkmcnt(7)
    v_pk_mul_f32 v[88:89], v[40:41], v[40:41]
    v_pk_mul_f32 v[90:91], v[42:43], v[42:43]
    v_pk_fma_f32 v[88:89], v[88:89], v[100:101], s[4:5]
    v_pk_fma_f32 v[90:91], v[90:91], v[100:101], s[4:5]
    v_pk_mul_f32 v[88:89], v[40:41], v[88:89]
    v_pk_mul_f32 v[90:91], v[42:43], v[90:91]
    v_exp_f32 v88, v88
    v_exp_f32 v89, v89
    v_exp_f32 v90, v90
    v_exp_f32 v91, v91
    v_pk_add_f32 v[88:89], v[88:89], 1.0 op_sel_hi:[1,0]
    v_pk_add_f32 v[90:91], v[90:91], 1.0 op_sel_hi:[1,0]
    v_rcp_f32 v88, v88
    v_rcp_f32 v89, v89
    v_rcp_f32 v90, v90
    v_rcp_f32 v91, v91
    v_pk_mul_f32 v[40:41], v[40:41], v[88:89]
    v_pk_mul_f32 v[42:43], v[42:43], v[90:91]
    v_cvt_pk_bf16_f32 v72, v40, v41
    v_cvt_pk_bf16_f32 v73, v42, v43
    s_waitcnt lgkmcnt(6)
    v_pk_mul_f32 v[88:89], v[44:45], v[44:45]
    v_pk_mul_f32 v[90:91], v[46:47], v[46:47]
    v_pk_fma_f32 v[88:89], v[88:89], v[100:101], s[4:5]
    v_pk_fma_f32 v[90:91], v[90:91], v[100:101], s[4:5]
    v_pk_mul_f32 v[88:89], v[44:45], v[88:89]
    v_pk_mul_f32 v[90:91], v[46:47], v[90:91]
    v_exp_f32 v88, v88
    v_exp_f32 v89, v89
    v_exp_f32 v90, v90
    v_exp_f32 v91, v91
    v_pk_add_f32 v[88:89], v[88:89], 1.0 op_sel_hi:[1,0]
    v_pk_add_f32 v[90:91], v[90:91], 1.0 op_sel_hi:[1,0]
    v_rcp_f32 v88, v88
    v_rcp_f32 v89, v89
    v_rcp_f32 v90, v90
    v_rcp_f32 v91, v91
    v_pk_mul_f32 v[44:45], v[44:45], v[88:89]
    v_pk_mul_f32 v[46:47], v[46:47], v[90:91]
    v_cvt_pk_bf16_f32 v74, v44, v45
    v_cvt_pk_bf16_f32 v75, v46, v47
    s_waitcnt lgkmcnt(5)
    v_pk_mul_f32 v[88:89], v[48:49], v[48:49]
    v_pk_mul_f32 v[90:91], v[50:51], v[50:51]
    v_pk_fma_f32 v[88:89], v[88:89], v[100:101], s[4:5]
    v_pk_fma_f32 v[90:91], v[90:91], v[100:101], s[4:5]
    v_pk_mul_f32 v[88:89], v[48:49], v[88:89]
    v_pk_mul_f32 v[90:91], v[50:51], v[90:91]
    v_exp_f32 v88, v88
    v_exp_f32 v89, v89
    v_exp_f32 v90, v90
    v_exp_f32 v91, v91
    v_pk_add_f32 v[88:89], v[88:89], 1.0 op_sel_hi:[1,0]
    v_pk_add_f32 v[90:91], v[90:91], 1.0 op_sel_hi:[1,0]
    v_rcp_f32 v88, v88
    v_rcp_f32 v89, v89
    v_rcp_f32 v90, v90
    v_rcp_f32 v91, v91
    v_pk_mul_f32 v[48:49], v[48:49], v[88:89]
    v_pk_mul_f32 v[50:51], v[50:51], v[90:91]
    v_cvt_pk_bf16_f32 v76, v48, v49
    v_cvt_pk_bf16_f32 v77, v50, v51
    s_waitcnt lgkmcnt(4)
    v_pk_mul_f32 v[88:89], v[52:53], v[52:53]
    v_pk_mul_f32 v[90:91], v[54:55], v[54:55]
    v_pk_fma_f32 v[88:89], v[88:89], v[100:101], s[4:5]
    v_pk_fma_f32 v[90:91], v[90:91], v[100:101], s[4:5]
    v_pk_mul_f32 v[88:89], v[52:53], v[88:89]
    v_pk_mul_f32 v[90:91], v[54:55], v[90:91]
    v_exp_f32 v88, v88
    v_exp_f32 v89, v89
    v_exp_f32 v90, v90
    v_exp_f32 v91, v91
    v_pk_add_f32 v[88:89], v[88:89], 1.0 op_sel_hi:[1,0]
    v_pk_add_f32 v[90:91], v[90:91], 1.0 op_sel_hi:[1,0]
    v_rcp_f32 v88, v88
    v_rcp_f32 v89, v89
    v_rcp_f32 v90, v90
    v_rcp_f32 v91, v91
    v_pk_mul_f32 v[52:53], v[52:53], v[88:89]
    v_pk_mul_f32 v[54:55], v[54:55], v[90:91]
    v_cvt_pk_bf16_f32 v78, v52, v53
    v_cvt_pk_bf16_f32 v79, v54, v55
    ds_write_b128 v32, v[72:75] offset:64
    ds_write_b128 v32, v[76:79] offset:96
    s_waitcnt lgkmcnt(5)
    v_pk_mul_f32 v[88:89], v[56:57], v[56:57]
    v_pk_mul_f32 v[90:91], v[58:59], v[58:59]
    v_pk_fma_f32 v[88:89], v[88:89], v[100:101], s[4:5]
    v_pk_fma_f32 v[90:91], v[90:91], v[100:101], s[4:5]
    v_pk_mul_f32 v[88:89], v[56:57], v[88:89]
    v_pk_mul_f32 v[90:91], v[58:59], v[90:91]
    v_exp_f32 v88, v88
    v_exp_f32 v89, v89
    v_exp_f32 v90, v90
    v_exp_f32 v91, v91
    v_pk_add_f32 v[88:89], v[88:89], 1.0 op_sel_hi:[1,0]
    v_pk_add_f32 v[90:91], v[90:91], 1.0 op_sel_hi:[1,0]
    v_rcp_f32 v88, v88
    v_rcp_f32 v89, v89
    v_rcp_f32 v90, v90
    v_rcp_f32 v91, v91
    v_pk_mul_f32 v[56:57], v[56:57], v[88:89]
    v_pk_mul_f32 v[58:59], v[58:59], v[90:91]
    v_cvt_pk_bf16_f32 v80, v56, v57
    v_cvt_pk_bf16_f32 v81, v58, v59
    s_waitcnt lgkmcnt(4)
    v_pk_mul_f32 v[88:89], v[60:61], v[60:61]
    v_pk_mul_f32 v[90:91], v[62:63], v[62:63]
    v_pk_fma_f32 v[88:89], v[88:89], v[100:101], s[4:5]
    v_pk_fma_f32 v[90:91], v[90:91], v[100:101], s[4:5]
    v_pk_mul_f32 v[88:89], v[60:61], v[88:89]
    v_pk_mul_f32 v[90:91], v[62:63], v[90:91]
    v_exp_f32 v88, v88
    v_exp_f32 v89, v89
    v_exp_f32 v90, v90
    v_exp_f32 v91, v91
    v_pk_add_f32 v[88:89], v[88:89], 1.0 op_sel_hi:[1,0]
    v_pk_add_f32 v[90:91], v[90:91], 1.0 op_sel_hi:[1,0]
    v_rcp_f32 v88, v88
    v_rcp_f32 v89, v89
    v_rcp_f32 v90, v90
    v_rcp_f32 v91, v91
    v_pk_mul_f32 v[60:61], v[60:61], v[88:89]
    v_pk_mul_f32 v[62:63], v[62:63], v[90:91]
    v_cvt_pk_bf16_f32 v82, v60, v61
    v_cvt_pk_bf16_f32 v83, v62, v63
    s_waitcnt lgkmcnt(3)
    v_pk_mul_f32 v[88:89], v[64:65], v[64:65]
    v_pk_mul_f32 v[90:91], v[66:67], v[66:67]
    v_pk_fma_f32 v[88:89], v[88:89], v[100:101], s[4:5]
    v_pk_fma_f32 v[90:91], v[90:91], v[100:101], s[4:5]
    v_pk_mul_f32 v[88:89], v[64:65], v[88:89]
    v_pk_mul_f32 v[90:91], v[66:67], v[90:91]
    v_exp_f32 v88, v88
    v_exp_f32 v89, v89
    v_exp_f32 v90, v90
    v_exp_f32 v91, v91
    v_pk_add_f32 v[88:89], v[88:89], 1.0 op_sel_hi:[1,0]
    v_pk_add_f32 v[90:91], v[90:91], 1.0 op_sel_hi:[1,0]
    v_rcp_f32 v88, v88
    v_rcp_f32 v89, v89
    v_rcp_f32 v90, v90
    v_rcp_f32 v91, v91
    v_pk_mul_f32 v[64:65], v[64:65], v[88:89]
    v_pk_mul_f32 v[66:67], v[66:67], v[90:91]
    v_cvt_pk_bf16_f32 v84, v64, v65
    v_cvt_pk_bf16_f32 v85, v66, v67
    s_waitcnt lgkmcnt(2)
    v_pk_mul_f32 v[88:89], v[68:69], v[68:69]
    v_pk_mul_f32 v[90:91], v[70:71], v[70:71]
    v_pk_fma_f32 v[88:89], v[88:89], v[100:101], s[4:5]
    v_pk_fma_f32 v[90:91], v[90:91], v[100:101], s[4:5]
    v_pk_mul_f32 v[88:89], v[68:69], v[88:89]
    v_pk_mul_f32 v[90:91], v[70:71], v[90:91]
    v_exp_f32 v88, v88
    v_exp_f32 v89, v89
    v_exp_f32 v90, v90
    v_exp_f32 v91, v91
    v_pk_add_f32 v[88:89], v[88:89], 1.0 op_sel_hi:[1,0]
    v_pk_add_f32 v[90:91], v[90:91], 1.0 op_sel_hi:[1,0]
    v_rcp_f32 v88, v88
    v_rcp_f32 v89, v89
    v_rcp_f32 v90, v90
    v_rcp_f32 v91, v91
    v_pk_mul_f32 v[68:69], v[68:69], v[88:89]
    v_pk_mul_f32 v[70:71], v[70:71], v[90:91]
    v_cvt_pk_bf16_f32 v86, v68, v69
    v_cvt_pk_bf16_f32 v87, v70, v71
    ds_write_b128 v32, v[80:83] offset:8512
    ds_write_b128 v32, v[84:87] offset:8544
    s_waitcnt lgkmcnt(0)
    s_buffer_load_dword s65, s[40:43], s61
    s_waitcnt lgkmcnt(0)
    s_barrier
    s_cmp_lg_u32 s65, 4
    s_cbranch_scc1 L_ge
    v_lshlrev_b32 v5, 4, v1
    buffer_load_dwordx4 v[104:107], v5, s[52:55], s60 offen sc1
    buffer_load_dwordx4 v[108:111], v5, s[52:55], s60 offen offset:1024 sc1
    s_branch L_ge_done
L_ge:
    s_waitcnt vmcnt(0) lgkmcnt(0)
    s_mov_b32 s58, 0
    buffer_load_dwordx4 v[40:43], v10, s[28:31], s58 offen
    buffer_load_dwordx4 v[44:47], v11, s[28:31], s58 offen offset:1024
    buffer_load_dwordx4 v[72:75], v39, s[20:23], 0 offen
    s_mov_b32 s58, 8192
    buffer_load_dwordx4 v[48:51], v10, s[28:31], s58 offen
    buffer_load_dwordx4 v[52:55], v11, s[28:31], s58 offen offset:1024
    buffer_load_dwordx4 v[76:79], v39, s[20:23], 0 offen offset:32
    s_mov_b32 s58, 16384
    buffer_load_dwordx4 v[56:59], v10, s[28:31], s58 offen
    buffer_load_dwordx4 v[60:63], v11, s[28:31], s58 offen offset:1024
    buffer_load_dwordx4 v[80:83], v39, s[20:23], 0 offen offset:64
    s_waitcnt vmcnt(8)
    ds_write_b128 v24, v[40:43]
    s_waitcnt vmcnt(7)
    ds_write_b128 v24, v[44:47] offset:1024
    ds_read_b64_tr_b16 v[88:89], v14
    ds_read_b64_tr_b16 v[90:91], v14 offset:512
    ds_read_b64_tr_b16 v[92:93], v15
    ds_read_b64_tr_b16 v[94:95], v15 offset:512
    s_mov_b32 s58, 24576
    buffer_load_dwordx4 v[64:67], v10, s[28:31], s58 offen
    buffer_load_dwordx4 v[68:71], v11, s[28:31], s58 offen offset:1024
    buffer_load_dwordx4 v[84:87], v39, s[20:23], 0 offen offset:96
    s_waitcnt vmcnt(8)
    ds_write_b128 v24, v[48:51] offset:2048
    s_waitcnt vmcnt(7)
    ds_write_b128 v24, v[52:55] offset:3072
    ds_read_b64_tr_b16 v[96:97], v14 offset:2048
    ds_read_b64_tr_b16 v[98:99], v14 offset:2560
    ds_read_b64_tr_b16 v[100:101], v15 offset:2048
    ds_read_b64_tr_b16 v[102:103], v15 offset:2560
    s_waitcnt lgkmcnt(8)
    v_mfma_f32_16x16x32_bf16 v[104:107], v[88:91], v[72:75], 0
    s_waitcnt lgkmcnt(6)
    v_mfma_f32_16x16x32_bf16 v[108:111], v[92:95], v[72:75], 0
    s_mov_b32 s58, 32768
    buffer_load_dwordx4 v[40:43], v10, s[28:31], s58 offen
    buffer_load_dwordx4 v[44:47], v11, s[28:31], s58 offen offset:1024
    buffer_load_dwordx4 v[72:75], v39, s[20:23], 0 offen offset:128
    s_waitcnt vmcnt(8)
    ds_write_b128 v24, v[56:59]
    s_waitcnt vmcnt(7)
    ds_write_b128 v24, v[60:63] offset:1024
    ds_read_b64_tr_b16 v[88:89], v14
    ds_read_b64_tr_b16 v[90:91], v14 offset:512
    ds_read_b64_tr_b16 v[92:93], v15
    ds_read_b64_tr_b16 v[94:95], v15 offset:512
    s_waitcnt lgkmcnt(8)
    v_mfma_f32_16x16x32_bf16 v[104:107], v[96:99], v[76:79], v[104:107]
    s_waitcnt lgkmcnt(6)
    v_mfma_f32_16x16x32_bf16 v[108:111], v[100:103], v[76:79], v[108:111]
    s_mov_b32 s58, 40960
    buffer_load_dwordx4 v[48:51], v10, s[28:31], s58 offen
    buffer_load_dwordx4 v[52:55], v11, s[28:31], s58 offen offset:1024
    buffer_load_dwordx4 v[76:79], v39, s[20:23], 0 offen offset:160
    s_waitcnt vmcnt(8)
    ds_write_b128 v24, v[64:67] offset:2048
    s_waitcnt vmcnt(7)
    ds_write_b128 v24, v[68:71] offset:3072
    ds_read_b64_tr_b16 v[96:97], v14 offset:2048
    ds_read_b64_tr_b16 v[98:99], v14 offset:2560
    ds_read_b64_tr_b16 v[100:101], v15 offset:2048
    ds_read_b64_tr_b16 v[102:103], v15 offset:2560
    s_waitcnt lgkmcnt(8)
    v_mfma_f32_16x16x32_bf16 v[104:107], v[88:91], v[80:83], v[104:107]
    s_waitcnt lgkmcnt(6)
    v_mfma_f32_16x16x32_bf16 v[108:111], v[92:95], v[80:83], v[108:111]
    s_mov_b32 s58, 49152
    buffer_load_dwordx4 v[56:59], v10, s[28:31], s58 offen
    buffer_load_dwordx4 v[60:63], v11, s[28:31], s58 offen offset:1024
    buffer_load_dwordx4 v[80:83], v39, s[20:23], 0 offen offset:192
    s_waitcnt vmcnt(8)
    ds_write_b128 v24, v[40:43]
    s_waitcnt vmcnt(7)
    ds_write_b128 v24, v[44:47] offset:1024
    ds_read_b64_tr_b16 v[88:89], v14
    ds_read_b64_tr_b16 v[90:91], v14 offset:512
    ds_read_b64_tr_b16 v[92:93], v15
    ds_read_b64_tr_b16 v[94:95], v15 offset:512
    s_waitcnt lgkmcnt(8)
    v_mfma_f32_16x16x32_bf16 v[104:107], v[96:99], v[84:87], v[104:107]
    s_waitcnt lgkmcnt(6)
    v_mfma_f32_16x16x32_bf16 v[108:111], v[100:103], v[84:87], v[108:111]
    s_mov_b32 s58, 57344
    buffer_load_dwordx4 v[64:67], v10, s[28:31], s58 offen
    buffer_load_dwordx4 v[68:71], v11, s[28:31], s58 offen offset:1024
    buffer_load_dwordx4 v[84:87], v39, s[20:23], 0 offen offset:224
    s_waitcnt vmcnt(8)
    ds_write_b128 v24, v[48:51] offset:2048
    s_waitcnt vmcnt(7)
    ds_write_b128 v24, v[52:55] offset:3072
    ds_read_b64_tr_b16 v[96:97], v14 offset:2048
    ds_read_b64_tr_b16 v[98:99], v14 offset:2560
    ds_read_b64_tr_b16 v[100:101], v15 offset:2048
    ds_read_b64_tr_b16 v[102:103], v15 offset:2560
    s_waitcnt lgkmcnt(8)
    v_mfma_f32_16x16x32_bf16 v[104:107], v[88:91], v[72:75], v[104:107]
    s_waitcnt lgkmcnt(6)
    v_mfma_f32_16x16x32_bf16 v[108:111], v[92:95], v[72:75], v[108:111]
    s_mov_b32 s58, 65536
    buffer_load_dwordx4 v[40:43], v10, s[28:31], s58 offen
    buffer_load_dwordx4 v[44:47], v11, s[28:31], s58 offen offset:1024
    buffer_load_dwordx4 v[72:75], v39, s[20:23], 0 offen offset:256
    s_waitcnt vmcnt(8)
    ds_write_b128 v24, v[56:59]
    s_waitcnt vmcnt(7)
    ds_write_b128 v24, v[60:63] offset:1024
    ds_read_b64_tr_b16 v[88:89], v14
    ds_read_b64_tr_b16 v[90:91], v14 offset:512
    ds_read_b64_tr_b16 v[92:93], v15
    ds_read_b64_tr_b16 v[94:95], v15 offset:512
    s_waitcnt lgkmcnt(8)
    v_mfma_f32_16x16x32_bf16 v[104:107], v[96:99], v[76:79], v[104:107]
    s_waitcnt lgkmcnt(6)
    v_mfma_f32_16x16x32_bf16 v[108:111], v[100:103], v[76:79], v[108:111]
    s_mov_b32 s58, 73728
    buffer_load_dwordx4 v[48:51], v10, s[28:31], s58 offen
    buffer_load_dwordx4 v[52:55], v11, s[28:31], s58 offen offset:1024
    buffer_load_dwordx4 v[76:79], v39, s[20:23], 0 offen offset:288
    s_waitcnt vmcnt(8)
    ds_write_b128 v24, v[64:67] offset:2048
    s_waitcnt vmcnt(7)
    ds_write_b128 v24, v[68:71] offset:3072
    ds_read_b64_tr_b16 v[96:97], v14 offset:2048
    ds_read_b64_tr_b16 v[98:99], v14 offset:2560
    ds_read_b64_tr_b16 v[100:101], v15 offset:2048
    ds_read_b64_tr_b16 v[102:103], v15 offset:2560
    s_waitcnt lgkmcnt(8)
    v_mfma_f32_16x16x32_bf16 v[104:107], v[88:91], v[80:83], v[104:107]
    s_waitcnt lgkmcnt(6)
    v_mfma_f32_16x16x32_bf16 v[108:111], v[92:95], v[80:83], v[108:111]
    s_mov_b32 s58, 81920
    buffer_load_dwordx4 v[56:59], v10, s[28:31], s58 offen
    buffer_load_dwordx4 v[60:63], v11, s[28:31], s58 offen offset:1024
    buffer_load_dwordx4 v[80:83], v39, s[20:23], 0 offen offset:320
    s_waitcnt vmcnt(8)
    ds_write_b128 v24, v[40:43]
    s_waitcnt vmcnt(7)
    ds_write_b128 v24, v[44:47] offset:1024
    ds_read_b64_tr_b16 v[88:89], v14
    ds_read_b64_tr_b16 v[90:91], v14 offset:512
    ds_read_b64_tr_b16 v[92:93], v15
    ds_read_b64_tr_b16 v[94:95], v15 offset:512
    s_waitcnt lgkmcnt(8)
    v_mfma_f32_16x16x32_bf16 v[104:107], v[96:99], v[84:87], v[104:107]
    s_waitcnt lgkmcnt(6)
    v_mfma_f32_16x16x32_bf16 v[108:111], v[100:103], v[84:87], v[108:111]
    s_mov_b32 s58, 90112
    buffer_load_dwordx4 v[64:67], v10, s[28:31], s58 offen
    buffer_load_dwordx4 v[68:71], v11, s[28:31], s58 offen offset:1024
    buffer_load_dwordx4 v[84:87], v39, s[20:23], 0 offen offset:352
    s_waitcnt vmcnt(8)
    ds_write_b128 v24, v[48:51] offset:2048
    s_waitcnt vmcnt(7)
    ds_write_b128 v24, v[52:55] offset:3072
    ds_read_b64_tr_b16 v[96:97], v14 offset:2048
    ds_read_b64_tr_b16 v[98:99], v14 offset:2560
    ds_read_b64_tr_b16 v[100:101], v15 offset:2048
    ds_read_b64_tr_b16 v[102:103], v15 offset:2560
    s_waitcnt lgkmcnt(8)
    v_mfma_f32_16x16x32_bf16 v[104:107], v[88:91], v[72:75], v[104:107]
    s_waitcnt lgkmcnt(6)
    v_mfma_f32_16x16x32_bf16 v[108:111], v[92:95], v[72:75], v[108:111]
    s_mov_b32 s58, 98304
    buffer_load_dwordx4 v[40:43], v10, s[28:31], s58 offen
    buffer_load_dwordx4 v[44:47], v11, s[28:31], s58 offen offset:1024
    buffer_load_dwordx4 v[72:75], v39, s[20:23], 0 offen offset:384
    s_waitcnt vmcnt(8)
    ds_write_b128 v24, v[56:59]
    s_waitcnt vmcnt(7)
    ds_write_b128 v24, v[60:63] offset:1024
    ds_read_b64_tr_b16 v[88:89], v14
    ds_read_b64_tr_b16 v[90:91], v14 offset:512
    ds_read_b64_tr_b16 v[92:93], v15
    ds_read_b64_tr_b16 v[94:95], v15 offset:512
    s_waitcnt lgkmcnt(8)
    v_mfma_f32_16x16x32_bf16 v[104:107], v[96:99], v[76:79], v[104:107]
    s_waitcnt lgkmcnt(6)
    v_mfma_f32_16x16x32_bf16 v[108:111], v[100:103], v[76:79], v[108:111]
    s_mov_b32 s58, 106496
    buffer_load_dwordx4 v[48:51], v10, s[28:31], s58 offen
    buffer_load_dwordx4 v[52:55], v11, s[28:31], s58 offen offset:1024
    buffer_load_dwordx4 v[76:79], v39, s[20:23], 0 offen offset:416
    s_waitcnt vmcnt(8)
    ds_write_b128 v24, v[64:67] offset:2048
    s_waitcnt vmcnt(7)
    ds_write_b128 v24, v[68:71] offset:3072
    ds_read_b64_tr_b16 v[96:97], v14 offset:2048
    ds_read_b64_tr_b16 v[98:99], v14 offset:2560
    ds_read_b64_tr_b16 v[100:101], v15 offset:2048
    ds_read_b64_tr_b16 v[102:103], v15 offset:2560
    s_waitcnt lgkmcnt(8)
    v_mfma_f32_16x16x32_bf16 v[104:107], v[88:91], v[80:83], v[104:107]
    s_waitcnt lgkmcnt(6)
    v_mfma_f32_16x16x32_bf16 v[108:111], v[92:95], v[80:83], v[108:111]
    s_mov_b32 s58, 114688
    buffer_load_dwordx4 v[56:59], v10, s[28:31], s58 offen
    buffer_load_dwordx4 v[60:63], v11, s[28:31], s58 offen offset:1024
    buffer_load_dwordx4 v[80:83], v39, s[20:23], 0 offen offset:448
    s_waitcnt vmcnt(8)
    ds_write_b128 v24, v[40:43]
    s_waitcnt vmcnt(7)
    ds_write_b128 v24, v[44:47] offset:1024
    ds_read_b64_tr_b16 v[88:89], v14
    ds_read_b64_tr_b16 v[90:91], v14 offset:512
    ds_read_b64_tr_b16 v[92:93], v15
    ds_read_b64_tr_b16 v[94:95], v15 offset:512
    s_waitcnt lgkmcnt(8)
    v_mfma_f32_16x16x32_bf16 v[104:107], v[96:99], v[84:87], v[104:107]
    s_waitcnt lgkmcnt(6)
    v_mfma_f32_16x16x32_bf16 v[108:111], v[100:103], v[84:87], v[108:111]
    s_mov_b32 s58, 122880
    buffer_load_dwordx4 v[64:67], v10, s[28:31], s58 offen
    buffer_load_dwordx4 v[68:71], v11, s[28:31], s58 offen offset:1024
    buffer_load_dwordx4 v[84:87], v39, s[20:23], 0 offen offset:480
    s_waitcnt vmcnt(8)
    ds_write_b128 v24, v[48:51] offset:2048
    s_waitcnt vmcnt(7)
    ds_write_b128 v24, v[52:55] offset:3072
    ds_read_b64_tr_b16 v[96:97], v14 offset:2048
    ds_read_b64_tr_b16 v[98:99], v14 offset:2560
    ds_read_b64_tr_b16 v[100:101], v15 offset:2048
    ds_read_b64_tr_b16 v[102:103], v15 offset:2560
    s_waitcnt lgkmcnt(8)
    v_mfma_f32_16x16x32_bf16 v[104:107], v[88:91], v[72:75], v[104:107]
    s_waitcnt lgkmcnt(6)
    v_mfma_f32_16x16x32_bf16 v[108:111], v[92:95], v[72:75], v[108:111]
    s_waitcnt vmcnt(5)
    ds_write_b128 v24, v[56:59]
    s_waitcnt vmcnt(4)
    ds_write_b128 v24, v[60:63] offset:1024
    ds_read_b64_tr_b16 v[88:89], v14
    ds_read_b64_tr_b16 v[90:91], v14 offset:512
    ds_read_b64_tr_b16 v[92:93], v15
    ds_read_b64_tr_b16 v[94:95], v15 offset:512
    s_waitcnt lgkmcnt(8)
    v_mfma_f32_16x16x32_bf16 v[104:107], v[96:99], v[76:79], v[104:107]
    s_waitcnt lgkmcnt(6)
    v_mfma_f32_16x16x32_bf16 v[108:111], v[100:103], v[76:79], v[108:111]
    s_waitcnt vmcnt(2)
    ds_write_b128 v24, v[64:67] offset:2048
    s_waitcnt vmcnt(1)
    ds_write_b128 v24, v[68:71] offset:3072
    ds_read_b64_tr_b16 v[96:97], v14 offset:2048
    ds_read_b64_tr_b16 v[98:99], v14 offset:2560
    ds_read_b64_tr_b16 v[100:101], v15 offset:2048
    ds_read_b64_tr_b16 v[102:103], v15 offset:2560
    s_waitcnt lgkmcnt(8)
    v_mfma_f32_16x16x32_bf16 v[104:107], v[88:91], v[80:83], v[104:107]
    s_waitcnt lgkmcnt(6)
    v_mfma_f32_16x16x32_bf16 v[108:111], v[92:95], v[80:83], v[108:111]
    s_waitcnt vmcnt(0) lgkmcnt(2)
    v_mfma_f32_16x16x32_bf16 v[104:107], v[96:99], v[84:87], v[104:107]
    s_waitcnt lgkmcnt(0)
    v_mfma_f32_16x16x32_bf16 v[108:111], v[100:103], v[84:87], v[108:111]
    s_nop 9
    s_cmp_lt_u32 s2, 250
    s_cbranch_scc1 L_ge_done
    v_lshlrev_b32 v5, 4, v1
    buffer_store_dwordx4 v[104:107], v5, s[52:55], s60 offen sc0 sc1
    buffer_store_dwordx4 v[108:111], v5, s[52:55], s60 offen offset:1024 sc0 sc1
    s_waitcnt vmcnt(0)
    v_mov_b32 v2, 0
    v_mov_b32 v3, 1
    s_mov_b64 exec, 1
    buffer_atomic_add v3, v2, s[40:43], s61 offen sc1
    s_endpgm
L_ge_done:
    s_waitcnt lgkmcnt(0)
    s_waitcnt vmcnt(0)
    v_pk_mul_f32 v[112:113], v[104:105], s[6:7]
    v_pk_mul_f32 v[114:115], v[106:107], s[6:7]
    v_pk_mul_f32 v[116:117], v[108:109], s[6:7]
    v_pk_mul_f32 v[118:119], v[110:111], s[6:7]
    v_exp_f32 v120, v112
    v_exp_f32 v121, v113
    v_max3_f32 v23, |v112|, |v113|, v23
    v_exp_f32 v122, v114
    v_exp_f32 v123, v115
    v_max3_f32 v23, |v114|, |v115|, v23
    v_exp_f32 v124, v116
    v_exp_f32 v125, v117
    v_max3_f32 v23, |v116|, |v117|, v23
    v_exp_f32 v126, v118
    v_exp_f32 v127, v119
    v_max3_f32 v23, |v118|, |v119|, v23
    v_mul_f32 v120, -0.5, v120
    v_mul_f32 v121, -0.5, v121
    v_mul_f32 v122, -0.5, v122
    v_mul_f32 v123, -0.5, v123
    v_mul_f32 v124, -0.5, v124
    v_mul_f32 v125, -0.5, v125
    v_mul_f32 v126, -0.5, v126
    v_mul_f32 v127, -0.5, v127
    ds_write_b128 v25, v[120:123]
    ds_write_b128 v25, v[124:127] offset:64
    s_mov_b32 s67, 0x42fa0000
    v_cmp_lt_f32 vcc, s67, v23
    s_nop 1
    s_cmp_lg_u64 vcc, 0
    s_cselect_b32 s64, 1, 0
    s_lshl_b32 s65, s56, 2
    s_add_u32 s65, s65, 143376
    v_mov_b32 v2, s64
    v_mov_b32 v3, s65
    ds_write_b32 v3, v2
    s_waitcnt lgkmcnt(0)
    s_barrier
    s_mov_b32 s58, 98304
    buffer_load_dwordx4 v[56:59], v12, s[32:35], s58 offen
    buffer_load_dwordx4 v[60:63], v13, s[32:35], s58 offen offset:1024
    s_mov_b32 s58, 106496
    buffer_load_dwordx4 v[64:67], v12, s[32:35], s58 offen
    buffer_load_dwordx4 v[68:71], v13, s[32:35], s58 offen offset:1024
    s_mov_b32 s58, 114688
    buffer_load_dwordx4 v[72:75], v12, s[32:35], s58 offen
    buffer_load_dwordx4 v[76:79], v13, s[32:35], s58 offen offset:1024
    s_mov_b32 s58, 122880
    buffer_load_dwordx4 v[80:83], v12, s[32:35], s58 offen
    buffer_load_dwordx4 v[84:87], v13, s[32:35], s58 offen offset:1024
    s_barrier
    ds_read_b128 v[40:43], v24
    ds_read_b128 v[44:47], v24 offset:1024
    ds_read_b128 v[48:51], v24 offset:2048
    ds_read_b128 v[52:55], v24 offset:3072
    v_mov_b32 v100, 0xbdd2d3e8
    v_mov_b32 v101, 0xbdd2d3e8
    s_waitcnt lgkmcnt(3)
    v_pk_mul_f32 v[88:89], v[40:41], v[40:41]
    v_pk_mul_f32 v[90:91], v[42:43], v[42:43]
    v_pk_fma_f32 v[88:89], v[88:89], v[100:101], s[4:5]
    v_pk_fma_f32 v[90:91], v[90:91], v[100:101], s[4:5]
    v_pk_mul_f32 v[88:89], v[40:41], v[88:89]
    v_pk_mul_f32 v[90:91], v[42:43], v[90:91]
    v_exp_f32 v88, v88
    v_exp_f32 v89, v89
    v_exp_f32 v90, v90
    v_exp_f32 v91, v91
    v_pk_add_f32 v[88:89], v[88:89], 1.0 op_sel_hi:[1,0]
    v_pk_add_f32 v[90:91], v[90:91], 1.0 op_sel_hi:[1,0]
    v_rcp_f32 v88, v88
    v_rcp_f32 v89, v89
    v_rcp_f32 v90, v90
    v_rcp_f32 v91, v91
    v_pk_mul_f32 v[40:41], v[40:41], v[88:89]
    v_pk_mul_f32 v[42:43], v[42:43], v[90:91]
    v_cvt_pk_bf16_f32 v92, v40, v41
    v_cvt_pk_bf16_f32 v93, v42, v43
    s_waitcnt lgkmcnt(2)
    v_pk_mul_f32 v[88:89], v[44:45], v[44:45]
    v_pk_mul_f32 v[90:91], v[46:47], v[46:47]
    v_pk_fma_f32 v[88:89], v[88:89], v[100:101], s[4:5]
    v_pk_fma_f32 v[90:91], v[90:91], v[100:101], s[4:5]
    v_pk_mul_f32 v[88:89], v[44:45], v[88:89]
    v_pk_mul_f32 v[90:91], v[46:47], v[90:91]
    v_exp_f32 v88, v88
    v_exp_f32 v89, v89
    v_exp_f32 v90, v90
    v_exp_f32 v91, v91
    v_pk_add_f32 v[88:89], v[88:89], 1.0 op_sel_hi:[1,0]
    v_pk_add_f32 v[90:91], v[90:91], 1.0 op_sel_hi:[1,0]
    v_rcp_f32 v88, v88
    v_rcp_f32 v89, v89
    v_rcp_f32 v90, v90
    v_rcp_f32 v91, v91
    v_pk_mul_f32 v[44:45], v[44:45], v[88:89]
    v_pk_mul_f32 v[46:47], v[46:47], v[90:91]
    v_cvt_pk_bf16_f32 v94, v44, v45
    v_cvt_pk_bf16_f32 v95, v46, v47
    s_waitcnt lgkmcnt(1)
    v_pk_mul_f32 v[88:89], v[48:49], v[48:49]
    v_pk_mul_f32 v[90:91], v[50:51], v[50:51]
    v_pk_fma_f32 v[88:89], v[88:89], v[100:101], s[4:5]
    v_pk_fma_f32 v[90:91], v[90:91], v[100:101], s[4:5]
    v_pk_mul_f32 v[88:89], v[48:49], v[88:89]
    v_pk_mul_f32 v[90:91], v[50:51], v[90:91]
    v_exp_f32 v88, v88
    v_exp_f32 v89, v89
    v_exp_f32 v90, v90
    v_exp_f32 v91, v91
    v_pk_add_f32 v[88:89], v[88:89], 1.0 op_sel_hi:[1,0]
    v_pk_add_f32 v[90:91], v[90:91], 1.0 op_sel_hi:[1,0]
    v_rcp_f32 v88, v88
    v_rcp_f32 v89, v89
    v_rcp_f32 v90, v90
    v_rcp_f32 v91, v91
    v_pk_mul_f32 v[48:49], v[48:49], v[88:89]
    v_pk_mul_f32 v[50:51], v[50:51], v[90:91]
    v_cvt_pk_bf16_f32 v96, v48, v49
    v_cvt_pk_bf16_f32 v97, v50, v51
    s_waitcnt lgkmcnt(0)
    v_pk_mul_f32 v[88:89], v[52:53], v[52:53]
    v_pk_mul_f32 v[90:91], v[54:55], v[54:55]
    v_pk_fma_f32 v[88:89], v[88:89], v[100:101], s[4:5]
    v_pk_fma_f32 v[90:91], v[90:91], v[100:101], s[4:5]
    v_pk_mul_f32 v[88:89], v[52:53], v[88:89]
    v_pk_mul_f32 v[90:91], v[54:55], v[90:91]
    v_exp_f32 v88, v88
    v_exp_f32 v89, v89
    v_exp_f32 v90, v90
    v_exp_f32 v91, v91
    v_pk_add_f32 v[88:89], v[88:89], 1.0 op_sel_hi:[1,0]
    v_pk_add_f32 v[90:91], v[90:91], 1.0 op_sel_hi:[1,0]
    v_rcp_f32 v88, v88
    v_rcp_f32 v89, v89
    v_rcp_f32 v90, v90
    v_rcp_f32 v91, v91
    v_pk_mul_f32 v[52:53], v[52:53], v[88:89]
    v_pk_mul_f32 v[54:55], v[54:55], v[90:91]
    v_cvt_pk_bf16_f32 v98, v52, v53
    v_cvt_pk_bf16_f32 v99, v54, v55
    ds_write_b128 v37, v[92:95] offset:36928
    ds_write_b128 v37, v[96:99] offset:36960
    s_waitcnt lgkmcnt(0)
    s_barrier
    s_waitcnt vmcnt(7)
    ds_write_b128 v24, v[56:59]
    s_waitcnt vmcnt(6)
    ds_write_b128 v24, v[60:63] offset:1024
    ds_read_b64_tr_b16 v[128:129], v16
    ds_read_b64_tr_b16 v[130:131], v16 offset:512
    ds_read_b64_tr_b16 v[132:133], v17
    ds_read_b64_tr_b16 v[134:135], v17 offset:512
    s_waitcnt vmcnt(5)
    ds_write_b128 v24, v[64:67] offset:2048
    s_waitcnt vmcnt(4)
    ds_write_b128 v24, v[68:71] offset:3072
    ds_read_b64_tr_b16 v[136:137], v16 offset:2048
    ds_read_b64_tr_b16 v[138:139], v16 offset:2560
    ds_read_b64_tr_b16 v[140:141], v17 offset:2048
    ds_read_b64_tr_b16 v[142:143], v17 offset:2560
    s_waitcnt lgkmcnt(6)
    s_waitcnt vmcnt(3)
    ds_write_b128 v24, v[72:75]
    s_waitcnt vmcnt(2)
    ds_write_b128 v24, v[76:79] offset:1024
    ds_read_b64_tr_b16 v[144:145], v16
    ds_read_b64_tr_b16 v[146:147], v16 offset:512
    ds_read_b64_tr_b16 v[148:149], v17
    ds_read_b64_tr_b16 v[150:151], v17 offset:512
    s_waitcnt lgkmcnt(6)
    s_waitcnt vmcnt(1)
    ds_write_b128 v24, v[80:83] offset:2048
    s_waitcnt vmcnt(0)
    ds_write_b128 v24, v[84:87] offset:3072
    ds_read_b64_tr_b16 v[152:153], v16 offset:2048
    ds_read_b64_tr_b16 v[154:155], v16 offset:2560
    ds_read_b64_tr_b16 v[156:157], v17 offset:2048
    ds_read_b64_tr_b16 v[158:159], v17 offset:2560
    s_waitcnt lgkmcnt(0)
    s_barrier
    v_mov_b32 v3, 143360
    ds_read_b128 v[4:7], v3
    s_waitcnt lgkmcnt(0)
    v_or3_b32 v2, v4, v5, v6
    v_or_b32 v2, v2, v7
    ds_read_b128 v[4:7], v3 offset:16
    s_waitcnt lgkmcnt(0)
    v_or3_b32 v2, v4, v5, v2
    v_or3_b32 v2, v6, v7, v2
    s_nop 0
    v_readfirstlane_b32 s64, v2
    s_nop 4
    s_cmp_lg_u32 s64, 0
    s_cbranch_scc1 L_h_slow
    s_mov_b32 s49, 16896
    s_mov_b32 s50, 93216
    s_mov_b32 s51, 4294857184
    ds_read_b128 v[40:43], v27
    ds_read_b128 v[44:47], v27 offset:512
    ds_read_b128 v[48:51], v27 offset:1024
    ds_read_b128 v[52:55], v27 offset:1536
    ds_read_b128 v[56:59], v26
    ds_read_b128 v[60:63], v26 offset:512
    v_add_u32 v26, 4160, v26
    s_waitcnt lgkmcnt(1)
    v_pk_fma_f32 v[64:65], v[56:57], v[40:41], -0.5 op_sel_hi:[1,1,0]
    v_pk_fma_f32 v[66:67], v[58:59], v[42:43], -0.5 op_sel_hi:[1,1,0]
    s_waitcnt lgkmcnt(0)
    v_pk_fma_f32 v[68:69], v[60:61], v[44:45], -0.5 op_sel_hi:[1,1,0]
    v_pk_fma_f32 v[70:71], v[62:63], v[46:47], -0.5 op_sel_hi:[1,1,0]
    v_rcp_f32 v64, v64
    v_rcp_f32 v65, v65
    v_rcp_f32 v66, v66
    v_rcp_f32 v67, v67
    v_pk_add_f32 v[64:65], v[64:65], 1.0 op_sel_hi:[1,0]
    v_pk_add_f32 v[66:67], v[66:67], 1.0 op_sel_hi:[1,0]
    v_cvt_pk_bf16_f32 v72, v64, v65
    v_cvt_pk_bf16_f32 v73, v66, v67
    v_rcp_f32 v68, v68
    v_rcp_f32 v69, v69
    v_rcp_f32 v70, v70
    v_rcp_f32 v71, v71
    v_pk_add_f32 v[68:69], v[68:69], 1.0 op_sel_hi:[1,0]
    v_pk_add_f32 v[70:71], v[70:71], 1.0 op_sel_hi:[1,0]
    v_cvt_pk_bf16_f32 v74, v68, v69
    v_cvt_pk_bf16_f32 v75, v70, v71
    ds_write_b128 v33, v[72:75]
    v_pk_fma_f32 v[64:65], v[56:57], v[48:49], -0.5 op_sel_hi:[1,1,0]
    v_pk_fma_f32 v[66:67], v[58:59], v[50:51], -0.5 op_sel_hi:[1,1,0]
    v_pk_fma_f32 v[68:69], v[60:61], v[52:53], -0.5 op_sel_hi:[1,1,0]
    v_pk_fma_f32 v[70:71], v[62:63], v[54:55], -0.5 op_sel_hi:[1,1,0]
    ds_read_b128 v[56:59], v26
    ds_read_b128 v[60:63], v26 offset:512
    v_add_u32 v26, 4160, v26
    v_rcp_f32 v64, v64
    v_rcp_f32 v65, v65
    v_rcp_f32 v66, v66
    v_rcp_f32 v67, v67
    v_pk_add_f32 v[64:65], v[64:65], 1.0 op_sel_hi:[1,0]
    v_pk_add_f32 v[66:67], v[66:67], 1.0 op_sel_hi:[1,0]
    v_cvt_pk_bf16_f32 v72, v64, v65
    v_cvt_pk_bf16_f32 v73, v66, v67
    v_rcp_f32 v68, v68
    v_rcp_f32 v69, v69
    v_rcp_f32 v70, v70
    v_rcp_f32 v71, v71
    v_pk_add_f32 v[68:69], v[68:69], 1.0 op_sel_hi:[1,0]
    v_pk_add_f32 v[70:71], v[70:71], 1.0 op_sel_hi:[1,0]
    v_cvt_pk_bf16_f32 v74, v68, v69
    v_cvt_pk_bf16_f32 v75, v70, v71
    ds_write_b128 v33, v[72:75] offset:528
    s_waitcnt lgkmcnt(2)
    v_pk_fma_f32 v[64:65], v[56:57], v[40:41], -0.5 op_sel_hi:[1,1,0]
    v_pk_fma_f32 v[66:67], v[58:59], v[42:43], -0.5 op_sel_hi:[1,1,0]
    s_waitcnt lgkmcnt(1)
    v_pk_fma_f32 v[68:69], v[60:61], v[44:45], -0.5 op_sel_hi:[1,1,0]
    v_pk_fma_f32 v[70:71], v[62:63], v[46:47], -0.5 op_sel_hi:[1,1,0]
    v_rcp_f32 v64, v64
    v_rcp_f32 v65, v65
    v_rcp_f32 v66, v66
    v_rcp_f32 v67, v67
    v_pk_add_f32 v[64:65], v[64:65], 1.0 op_sel_hi:[1,0]
    v_pk_add_f32 v[66:67], v[66:67], 1.0 op_sel_hi:[1,0]
    v_cvt_pk_bf16_f32 v72, v64, v65
    v_cvt_pk_bf16_f32 v73, v66, v67
    v_rcp_f32 v68, v68
    v_rcp_f32 v69, v69
    v_rcp_f32 v70, v70
    v_rcp_f32 v71, v71
    v_pk_add_f32 v[68:69], v[68:69], 1.0 op_sel_hi:[1,0]
    v_pk_add_f32 v[70:71], v[70:71], 1.0 op_sel_hi:[1,0]
    v_cvt_pk_bf16_f32 v74, v68, v69
    v_cvt_pk_bf16_f32 v75, v70, v71
    ds_write_b128 v34, v[72:75]
    v_pk_fma_f32 v[64:65], v[56:57], v[48:49], -0.5 op_sel_hi:[1,1,0]
    v_pk_fma_f32 v[66:67], v[58:59], v[50:51], -0.5 op_sel_hi:[1,1,0]
    v_pk_fma_f32 v[68:69], v[60:61], v[52:53], -0.5 op_sel_hi:[1,1,0]
    v_pk_fma_f32 v[70:71], v[62:63], v[54:55], -0.5 op_sel_hi:[1,1,0]
    ds_read_b128 v[56:59], v26
    ds_read_b128 v[60:63], v26 offset:512
    v_add_u32 v26, 4160, v26
    v_rcp_f32 v64, v64
    v_rcp_f32 v65, v65
    v_rcp_f32 v66, v66
    v_rcp_f32 v67, v67
    v_pk_add_f32 v[64:65], v[64:65], 1.0 op_sel_hi:[1,0]
    v_pk_add_f32 v[66:67], v[66:67], 1.0 op_sel_hi:[1,0]
    v_cvt_pk_bf16_f32 v72, v64, v65
    v_cvt_pk_bf16_f32 v73, v66, v67
    v_rcp_f32 v68, v68
    v_rcp_f32 v69, v69
    v_rcp_f32 v70, v70
    v_rcp_f32 v71, v71
    v_pk_add_f32 v[68:69], v[68:69], 1.0 op_sel_hi:[1,0]
    v_pk_add_f32 v[70:71], v[70:71], 1.0 op_sel_hi:[1,0]
    v_cvt_pk_bf16_f32 v74, v68, v69
    v_cvt_pk_bf16_f32 v75, v70, v71
    ds_write_b128 v34, v[72:75] offset:528
    s_mov_b32 s68, 8
    s_mov_b32 s62, 0x7ff00000
    s_setprio 1
    s_waitcnt lgkmcnt(0)
    s_barrier
    ds_read_b128 v[120:123], v30
    ds_read_b128 v[124:127], v30 offset:32
    ds_read_b128 v[18:21], v30 offset:64
    s_waitcnt lgkmcnt(0)
L_h_loop:
    v_mfma_f32_32x32x16_bf16 v[40:55], a[0:3], v[120:123], 0
    ds_read_b128 v[4:7], v30 offset:96
    v_mfma_f32_32x32x16_bf16 v[56:71], a[4:7], v[120:123], 0
    v_cvt_pk_bf16_f32 v72, v72, v73
    v_cvt_pk_bf16_f32 v73, v74, v75
    v_mfma_f32_32x32x16_bf16 v[40:55], a[8:11], v[124:127], v[40:55]
    ds_read_b128 v[120:123], v30 offset:128
    v_cvt_pk_bf16_f32 v74, v76, v77
    v_cvt_pk_bf16_f32 v75, v78, v79
    v_mfma_f32_32x32x16_bf16 v[56:71], a[12:15], v[124:127], v[56:71]
    ds_write_b128 v36, v[72:75]
    v_cvt_pk_bf16_f32 v76, v80, v81
    v_mfma_f32_32x32x16_bf16 v[40:55], a[16:19], v[18:21], v[40:55]
    ds_read_b128 v[124:127], v30 offset:160
    v_cvt_pk_bf16_f32 v77, v82, v83
    v_cvt_pk_bf16_f32 v78, v84, v85
    v_mfma_f32_32x32x16_bf16 v[56:71], a[20:23], v[18:21], v[56:71]
    v_cvt_pk_bf16_f32 v79, v86, v87
    ds_write_b128 v36, v[76:79] offset:16
    s_waitcnt lgkmcnt(4)
    v_mfma_f32_32x32x16_bf16 v[40:55], a[24:27], v[4:7], v[40:55]
    ds_read_b128 v[18:21], v30 offset:192
    v_cvt_pk_bf16_f32 v80, v88, v89
    v_cvt_pk_bf16_f32 v81, v90, v91
    v_mfma_f32_32x32x16_bf16 v[56:71], a[28:31], v[4:7], v[56:71]
    v_cvt_pk_bf16_f32 v82, v92, v93
    v_cvt_pk_bf16_f32 v83, v94, v95
    s_waitcnt lgkmcnt(4)
    v_mfma_f32_32x32x16_bf16 v[40:55], a[32:35], v[120:123], v[40:55]
    ds_read_b128 v[4:7], v30 offset:224
    ds_write_b128 v36, v[80:83] offset:32
    v_cvt_pk_bf16_f32 v84, v96, v97
    v_mfma_f32_32x32x16_bf16 v[56:71], a[36:39], v[120:123], v[56:71]
    v_cvt_pk_bf16_f32 v85, v98, v99
    v_cvt_pk_bf16_f32 v86, v100, v101
    s_waitcnt lgkmcnt(4)
    v_mfma_f32_32x32x16_bf16 v[40:55], a[40:43], v[124:127], v[40:55]
    ds_read_b128 v[120:123], v30 offset:256
    v_cvt_pk_bf16_f32 v87, v102, v103
    ds_write_b128 v36, v[84:87] offset:48
    v_mfma_f32_32x32x16_bf16 v[56:71], a[44:47], v[124:127], v[56:71]
    ds_read_b128 v[88:91], v28
    s_waitcnt lgkmcnt(5)
    v_mfma_f32_32x32x16_bf16 v[40:55], a[48:51], v[18:21], v[40:55]
    ds_read_b128 v[124:127], v30 offset:288
    ds_read_b128 v[92:95], v28 offset:1152
    v_mfma_f32_32x32x16_bf16 v[56:71], a[52:55], v[18:21], v[56:71]
    ds_read_b128 v[96:99], v28 offset:2304
    s_waitcnt lgkmcnt(7)
    v_mfma_f32_32x32x16_bf16 v[40:55], a[56:59], v[4:7], v[40:55]
    ds_read_b128 v[18:21], v30 offset:320
    ds_read_b128 v[100:103], v28 offset:3456
    v_mfma_f32_32x32x16_bf16 v[56:71], a[60:63], v[4:7], v[56:71]
    s_waitcnt lgkmcnt(5)
    buffer_store_dwordx4 v[88:91], v29, s[36:39], s62 offen sc0 sc1 nt
    s_add_u32 s62, s62, 4096
    v_mfma_f32_32x32x16_bf16 v[40:55], a[64:67], v[120:123], v[40:55]
    ds_read_b128 v[4:7], v30 offset:352
    v_mfma_f32_32x32x16_bf16 v[56:71], a[68:71], v[120:123], v[56:71]
    s_waitcnt lgkmcnt(5)
    v_mfma_f32_32x32x16_bf16 v[40:55], a[72:75], v[124:127], v[40:55]
    ds_read_b128 v[120:123], v30 offset:384
    v_mfma_f32_32x32x16_bf16 v[56:71], a[76:79], v[124:127], v[56:71]
    s_waitcnt lgkmcnt(5)
    buffer_store_dwordx4 v[92:95], v29, s[36:39], s62 offen sc0 sc1 nt
    s_add_u32 s62, s62, 4096
    s_waitcnt lgkmcnt(3)
    v_mfma_f32_32x32x16_bf16 v[40:55], a[80:83], v[18:21], v[40:55]
    ds_read_b128 v[124:127], v30 offset:416
    v_mfma_f32_32x32x16_bf16 v[56:71], a[84:87], v[18:21], v[56:71]
    s_waitcnt lgkmcnt(2)
    v_mfma_f32_32x32x16_bf16 v[40:55], a[88:91], v[4:7], v[40:55]
    ds_read_b128 v[18:21], v30 offset:448
    v_mfma_f32_32x32x16_bf16 v[56:71], a[92:95], v[4:7], v[56:71]
    buffer_store_dwordx4 v[96:99], v29, s[36:39], s62 offen sc0 sc1 nt
    s_add_u32 s62, s62, 4096
    s_waitcnt lgkmcnt(2)
    v_mfma_f32_32x32x16_bf16 v[40:55], v[128:131], v[120:123], v[40:55]
    ds_read_b128 v[4:7], v30 offset:480
    v_mfma_f32_32x32x16_bf16 v[56:71], v[132:135], v[120:123], v[56:71]
    s_waitcnt lgkmcnt(2)
    v_mfma_f32_32x32x16_bf16 v[40:55], v[136:139], v[124:127], v[40:55]
    ds_read_b128 v[120:123], v31
    v_mfma_f32_32x32x16_bf16 v[56:71], v[140:143], v[124:127], v[56:71]
    buffer_store_dwordx4 v[100:103], v29, s[36:39], s62 offen sc0 sc1 nt
    s_add_u32 s62, s62, 4096
    s_waitcnt lgkmcnt(2)
    v_mfma_f32_32x32x16_bf16 v[40:55], v[144:147], v[18:21], v[40:55]
    ds_read_b128 v[124:127], v31 offset:32
    v_mfma_f32_32x32x16_bf16 v[56:71], v[148:151], v[18:21], v[56:71]
    s_waitcnt lgkmcnt(2)
    v_mfma_f32_32x32x16_bf16 v[72:87], v[152:155], v[4:7], v[40:55]
    ds_read_b128 v[18:21], v31 offset:64
    v_mfma_f32_32x32x16_bf16 v[88:103], v[156:159], v[4:7], v[56:71]
    v_mov_b32 v30, v31
    v_add_u32 v31, s50, v31
    s_mov_b32 s66, s49
    s_mov_b32 s49, s50
    s_mov_b32 s50, s51
    s_mov_b32 s51, s66
    s_cmp_eq_u32 s68, 8
    s_cselect_b32 s62, s63, s62
    s_sub_u32 s68, s68, 1
    s_cmp_lg_u32 s68, 0
    s_waitcnt lgkmcnt(0)
    s_barrier
    s_cbranch_scc1 L_h_loop
    v_cvt_pk_bf16_f32 v72, v72, v73
    v_cvt_pk_bf16_f32 v73, v74, v75
    v_cvt_pk_bf16_f32 v74, v76, v77
    v_cvt_pk_bf16_f32 v75, v78, v79
    ds_write_b128 v36, v[72:75]
    v_cvt_pk_bf16_f32 v76, v80, v81
    v_cvt_pk_bf16_f32 v77, v82, v83
    v_cvt_pk_bf16_f32 v78, v84, v85
    v_cvt_pk_bf16_f32 v79, v86, v87
    ds_write_b128 v36, v[76:79] offset:16
    v_cvt_pk_bf16_f32 v80, v88, v89
    v_cvt_pk_bf16_f32 v81, v90, v91
    v_cvt_pk_bf16_f32 v82, v92, v93
    v_cvt_pk_bf16_f32 v83, v94, v95
    ds_write_b128 v36, v[80:83] offset:32
    v_cvt_pk_bf16_f32 v84, v96, v97
    v_cvt_pk_bf16_f32 v85, v98, v99
    v_cvt_pk_bf16_f32 v86, v100, v101
    v_cvt_pk_bf16_f32 v87, v102, v103
    ds_write_b128 v36, v[84:87] offset:48
    ds_read_b128 v[88:91], v28
    ds_read_b128 v[92:95], v28 offset:1152
    ds_read_b128 v[96:99], v28 offset:2304
    ds_read_b128 v[100:103], v28 offset:3456
    s_waitcnt lgkmcnt(3)
    buffer_store_dwordx4 v[88:91], v29, s[36:39], s62 offen sc0 sc1 nt
    s_add_u32 s62, s62, 4096
    s_waitcnt lgkmcnt(2)
    buffer_store_dwordx4 v[92:95], v29, s[36:39], s62 offen sc0 sc1 nt
    s_add_u32 s62, s62, 4096
    s_waitcnt lgkmcnt(1)
    buffer_store_dwordx4 v[96:99], v29, s[36:39], s62 offen sc0 sc1 nt
    s_add_u32 s62, s62, 4096
    s_waitcnt lgkmcnt(0)
    buffer_store_dwordx4 v[100:103], v29, s[36:39], s62 offen sc0 sc1 nt
    s_add_u32 s62, s62, 4096
    s_endpgm
L_c_slow:
    s_nop 7
    s_barrier
    ds_write_b128 v46, v[128:131]
    ds_write_b128 v46, v[132:135] offset:512
    ds_write_b128 v46, v[136:139] offset:32
    ds_write_b128 v46, v[140:143] offset:544
    ds_write_b128 v46, v[144:147] offset:64
    ds_write_b128 v46, v[148:151] offset:576
    ds_write_b128 v46, v[152:155] offset:96
    ds_write_b128 v46, v[156:159] offset:608
    s_waitcnt lgkmcnt(0)
    s_barrier
    ds_read_b128 v[56:59], v51
    ds_read_b128 v[60:63], v51 offset:512
    ds_read_b128 v[64:67], v51 offset:1024
    ds_read_b128 v[68:71], v51 offset:1536
    ds_read_b128 v[72:75], v51 offset:2048
    ds_read_b128 v[76:79], v51 offset:2560
    ds_read_b128 v[80:83], v51 offset:3072
    ds_read_b128 v[84:87], v51 offset:3584
    ds_read_b128 v[88:91], v50
    ds_read_b128 v[92:95], v50 offset:512
    v_add_u32 v50, 4160, v50
    s_waitcnt lgkmcnt(1)
    v_add_f32 v96, v88, v56
    v_add_f32 v97, v89, v57
    v_add_f32 v98, v90, v58
    v_add_f32 v99, v91, v59
    s_waitcnt lgkmcnt(0)
    v_add_f32 v100, v92, v60
    v_add_f32 v101, v93, v61
    v_add_f32 v102, v94, v62
    v_add_f32 v103, v95, v63
    v_exp_f32 v96, v96
    v_exp_f32 v97, v97
    v_exp_f32 v98, v98
    v_exp_f32 v99, v99
    v_add_f32 v96, 1.0, v96
    v_add_f32 v97, 1.0, v97
    v_add_f32 v98, 1.0, v98
    v_add_f32 v99, 1.0, v99
    v_rcp_f32 v96, v96
    v_rcp_f32 v97, v97
    v_rcp_f32 v98, v98
    v_rcp_f32 v99, v99
    v_fma_f32 v96, v96, -2.0, 1.0
    v_fma_f32 v97, v97, -2.0, 1.0
    v_fma_f32 v98, v98, -2.0, 1.0
    v_fma_f32 v99, v99, -2.0, 1.0
    v_cvt_pk_bf16_f32 v104, v96, v97
    v_cvt_pk_bf16_f32 v105, v98, v99
    v_exp_f32 v100, v100
    v_exp_f32 v101, v101
    v_exp_f32 v102, v102
    v_exp_f32 v103, v103
    v_add_f32 v100, 1.0, v100
    v_add_f32 v101, 1.0, v101
    v_add_f32 v102, 1.0, v102
    v_add_f32 v103, 1.0, v103
    v_rcp_f32 v100, v100
    v_rcp_f32 v101, v101
    v_rcp_f32 v102, v102
    v_rcp_f32 v103, v103
    v_fma_f32 v100, v100, -2.0, 1.0
    v_fma_f32 v101, v101, -2.0, 1.0
    v_fma_f32 v102, v102, -2.0, 1.0
    v_fma_f32 v103, v103, -2.0, 1.0
    v_cvt_pk_bf16_f32 v106, v100, v101
    v_cvt_pk_bf16_f32 v107, v102, v103
    ds_write_b128 v18, v[104:107]
    v_add_f32 v96, v88, v64
    v_add_f32 v97, v89, v65
    v_add_f32 v98, v90, v66
    v_add_f32 v99, v91, v67
    v_add_f32 v100, v92, v68
    v_add_f32 v101, v93, v69
    v_add_f32 v102, v94, v70
    v_add_f32 v103, v95, v71
    ds_read_b128 v[88:91], v50
    ds_read_b128 v[92:95], v50 offset:512
    v_add_u32 v50, 4160, v50
    v_exp_f32 v96, v96
    v_exp_f32 v97, v97
    v_exp_f32 v98, v98
    v_exp_f32 v99, v99
    v_add_f32 v96, 1.0, v96
    v_add_f32 v97, 1.0, v97
    v_add_f32 v98, 1.0, v98
    v_add_f32 v99, 1.0, v99
    v_rcp_f32 v96, v96
    v_rcp_f32 v97, v97
    v_rcp_f32 v98, v98
    v_rcp_f32 v99, v99
    v_fma_f32 v96, v96, -2.0, 1.0
    v_fma_f32 v97, v97, -2.0, 1.0
    v_fma_f32 v98, v98, -2.0, 1.0
    v_fma_f32 v99, v99, -2.0, 1.0
    v_cvt_pk_bf16_f32 v104, v96, v97
    v_cvt_pk_bf16_f32 v105, v98, v99
    v_exp_f32 v100, v100
    v_exp_f32 v101, v101
    v_exp_f32 v102, v102
    v_exp_f32 v103, v103
    v_add_f32 v100, 1.0, v100
    v_add_f32 v101, 1.0, v101
    v_add_f32 v102, 1.0, v102
    v_add_f32 v103, 1.0, v103
    v_rcp_f32 v100, v100
    v_rcp_f32 v101, v101
    v_rcp_f32 v102, v102
    v_rcp_f32 v103, v103
    v_fma_f32 v100, v100, -2.0, 1.0
    v_fma_f32 v101, v101, -2.0, 1.0
    v_fma_f32 v102, v102, -2.0, 1.0
    v_fma_f32 v103, v103, -2.0, 1.0
    v_cvt_pk_bf16_f32 v106, v100, v101
    v_cvt_pk_bf16_f32 v107, v102, v103
    ds_write_b128 v18, v[104:107] offset:528
    s_waitcnt lgkmcnt(2)
    v_add_f32 v96, v88, v56
    v_add_f32 v97, v89, v57
    v_add_f32 v98, v90, v58
    v_add_f32 v99, v91, v59
    s_waitcnt lgkmcnt(1)
    v_add_f32 v100, v92, v60
    v_add_f32 v101, v93, v61
    v_add_f32 v102, v94, v62
    v_add_f32 v103, v95, v63
    v_exp_f32 v96, v96
    v_exp_f32 v97, v97
    v_exp_f32 v98, v98
    v_exp_f32 v99, v99
    v_add_f32 v96, 1.0, v96
    v_add_f32 v97, 1.0, v97
    v_add_f32 v98, 1.0, v98
    v_add_f32 v99, 1.0, v99
    v_rcp_f32 v96, v96
    v_rcp_f32 v97, v97
    v_rcp_f32 v98, v98
    v_rcp_f32 v99, v99
    v_fma_f32 v96, v96, -2.0, 1.0
    v_fma_f32 v97, v97, -2.0, 1.0
    v_fma_f32 v98, v98, -2.0, 1.0
    v_fma_f32 v99, v99, -2.0, 1.0
    v_cvt_pk_bf16_f32 v104, v96, v97
    v_cvt_pk_bf16_f32 v105, v98, v99
    v_exp_f32 v100, v100
    v_exp_f32 v101, v101
    v_exp_f32 v102, v102
    v_exp_f32 v103, v103
    v_add_f32 v100, 1.0, v100
    v_add_f32 v101, 1.0, v101
    v_add_f32 v102, 1.0, v102
    v_add_f32 v103, 1.0, v103
    v_rcp_f32 v100, v100
    v_rcp_f32 v101, v101
    v_rcp_f32 v102, v102
    v_rcp_f32 v103, v103
    v_fma_f32 v100, v100, -2.0, 1.0
    v_fma_f32 v101, v101, -2.0, 1.0
    v_fma_f32 v102, v102, -2.0, 1.0
    v_fma_f32 v103, v103, -2.0, 1.0
    v_cvt_pk_bf16_f32 v106, v100, v101
    v_cvt_pk_bf16_f32 v107, v102, v103
    ds_write_b128 v19, v[104:107]
    v_add_f32 v96, v88, v64
    v_add_f32 v97, v89, v65
    v_add_f32 v98, v90, v66
    v_add_f32 v99, v91, v67
    v_add_f32 v100, v92, v68
    v_add_f32 v101, v93, v69
    v_add_f32 v102, v94, v70
    v_add_f32 v103, v95, v71
    ds_read_b128 v[88:91], v50
    ds_read_b128 v[92:95], v50 offset:512
    v_add_u32 v50, 4160, v50
    v_exp_f32 v96, v96
    v_exp_f32 v97, v97
    v_exp_f32 v98, v98
    v_exp_f32 v99, v99
    v_add_f32 v96, 1.0, v96
    v_add_f32 v97, 1.0, v97
    v_add_f32 v98, 1.0, v98
    v_add_f32 v99, 1.0, v99
    v_rcp_f32 v96, v96
    v_rcp_f32 v97, v97
    v_rcp_f32 v98, v98
    v_rcp_f32 v99, v99
    v_fma_f32 v96, v96, -2.0, 1.0
    v_fma_f32 v97, v97, -2.0, 1.0
    v_fma_f32 v98, v98, -2.0, 1.0
    v_fma_f32 v99, v99, -2.0, 1.0
    v_cvt_pk_bf16_f32 v104, v96, v97
    v_cvt_pk_bf16_f32 v105, v98, v99
    v_exp_f32 v100, v100
    v_exp_f32 v101, v101
    v_exp_f32 v102, v102
    v_exp_f32 v103, v103
    v_add_f32 v100, 1.0, v100
    v_add_f32 v101, 1.0, v101
    v_add_f32 v102, 1.0, v102
    v_add_f32 v103, 1.0, v103
    v_rcp_f32 v100, v100
    v_rcp_f32 v101, v101
    v_rcp_f32 v102, v102
    v_rcp_f32 v103, v103
    v_fma_f32 v100, v100, -2.0, 1.0
    v_fma_f32 v101, v101, -2.0, 1.0
    v_fma_f32 v102, v102, -2.0, 1.0
    v_fma_f32 v103, v103, -2.0, 1.0
    v_cvt_pk_bf16_f32 v106, v100, v101
    v_cvt_pk_bf16_f32 v107, v102, v103
    ds_write_b128 v19, v[104:107] offset:528
    s_mov_b32 s68, 6
    s_waitcnt lgkmcnt(0)
    s_barrier
L_c_loops:
    v_add_f32 v96, v88, v56
    v_add_f32 v97, v89, v57
    v_add_f32 v98, v90, v58
    v_add_f32 v99, v91, v59
    v_add_f32 v100, v92, v60
    v_add_f32 v101, v93, v61
    v_add_f32 v102, v94, v62
    v_add_f32 v103, v95, v63
    v_exp_f32 v96, v96
    v_exp_f32 v97, v97
    v_exp_f32 v98, v98
    v_exp_f32 v99, v99
    v_add_f32 v96, 1.0, v96
    v_add_f32 v97, 1.0, v97
    v_add_f32 v98, 1.0, v98
    v_add_f32 v99, 1.0, v99
    v_rcp_f32 v96, v96
    v_rcp_f32 v97, v97
    v_rcp_f32 v98, v98
    v_rcp_f32 v99, v99
    v_fma_f32 v96, v96, -2.0, 1.0
    v_fma_f32 v97, v97, -2.0, 1.0
    v_fma_f32 v98, v98, -2.0, 1.0
    v_fma_f32 v99, v99, -2.0, 1.0
    v_cvt_pk_bf16_f32 v104, v96, v97
    v_cvt_pk_bf16_f32 v105, v98, v99
    v_exp_f32 v100, v100
    v_exp_f32 v101, v101
    v_exp_f32 v102, v102
    v_exp_f32 v103, v103
    v_add_f32 v100, 1.0, v100
    v_add_f32 v101, 1.0, v101
    v_add_f32 v102, 1.0, v102
    v_add_f32 v103, 1.0, v103
    v_rcp_f32 v100, v100
    v_rcp_f32 v101, v101
    v_rcp_f32 v102, v102
    v_rcp_f32 v103, v103
    v_fma_f32 v100, v100, -2.0, 1.0
    v_fma_f32 v101, v101, -2.0, 1.0
    v_fma_f32 v102, v102, -2.0, 1.0
    v_fma_f32 v103, v103, -2.0, 1.0
    v_cvt_pk_bf16_f32 v106, v100, v101
    v_cvt_pk_bf16_f32 v107, v102, v103
    ds_write_b128 v20, v[104:107]
    v_add_f32 v96, v88, v64
    v_add_f32 v97, v89, v65
    v_add_f32 v98, v90, v66
    v_add_f32 v99, v91, v67
    v_add_f32 v100, v92, v68
    v_add_f32 v101, v93, v69
    v_add_f32 v102, v94, v70
    v_add_f32 v103, v95, v71
    v_exp_f32 v96, v96
    v_exp_f32 v97, v97
    v_exp_f32 v98, v98
    v_exp_f32 v99, v99
    v_add_f32 v96, 1.0, v96
    v_add_f32 v97, 1.0, v97
    v_add_f32 v98, 1.0, v98
    v_add_f32 v99, 1.0, v99
    v_rcp_f32 v96, v96
    v_rcp_f32 v97, v97
    v_rcp_f32 v98, v98
    v_rcp_f32 v99, v99
    v_fma_f32 v96, v96, -2.0, 1.0
    v_fma_f32 v97, v97, -2.0, 1.0
    v_fma_f32 v98, v98, -2.0, 1.0
    v_fma_f32 v99, v99, -2.0, 1.0
    v_cvt_pk_bf16_f32 v104, v96, v97
    v_cvt_pk_bf16_f32 v105, v98, v99
    v_exp_f32 v100, v100
    v_exp_f32 v101, v101
    v_exp_f32 v102, v102
    v_exp_f32 v103, v103
    v_add_f32 v100, 1.0, v100
    v_add_f32 v101, 1.0, v101
    v_add_f32 v102, 1.0, v102
    v_add_f32 v103, 1.0, v103
    v_rcp_f32 v100, v100
    v_rcp_f32 v101, v101
    v_rcp_f32 v102, v102
    v_rcp_f32 v103, v103
    v_fma_f32 v100, v100, -2.0, 1.0
    v_fma_f32 v101, v101, -2.0, 1.0
    v_fma_f32 v102, v102, -2.0, 1.0
    v_fma_f32 v103, v103, -2.0, 1.0
    v_cvt_pk_bf16_f32 v106, v100, v101
    v_cvt_pk_bf16_f32 v107, v102, v103
    ds_write_b128 v20, v[104:107] offset:528
    v_add_f32 v96, v88, v72
    v_add_f32 v97, v89, v73
    v_add_f32 v98, v90, v74
    v_add_f32 v99, v91, v75
    v_add_f32 v100, v92, v76
    v_add_f32 v101, v93, v77
    v_add_f32 v102, v94, v78
    v_add_f32 v103, v95, v79
    v_exp_f32 v96, v96
    v_exp_f32 v97, v97
    v_exp_f32 v98, v98
    v_exp_f32 v99, v99
    v_add_f32 v96, 1.0, v96
    v_add_f32 v97, 1.0, v97
    v_add_f32 v98, 1.0, v98
    v_add_f32 v99, 1.0, v99
    v_rcp_f32 v96, v96
    v_rcp_f32 v97, v97
    v_rcp_f32 v98, v98
    v_rcp_f32 v99, v99
    v_fma_f32 v96, v96, -2.0, 1.0
    v_fma_f32 v97, v97, -2.0, 1.0
    v_fma_f32 v98, v98, -2.0, 1.0
    v_fma_f32 v99, v99, -2.0, 1.0
    v_cvt_pk_bf16_f32 v104, v96, v97
    v_cvt_pk_bf16_f32 v105, v98, v99
    v_exp_f32 v100, v100
    v_exp_f32 v101, v101
    v_exp_f32 v102, v102
    v_exp_f32 v103, v103
    v_add_f32 v100, 1.0, v100
    v_add_f32 v101, 1.0, v101
    v_add_f32 v102, 1.0, v102
    v_add_f32 v103, 1.0, v103
    v_rcp_f32 v100, v100
    v_rcp_f32 v101, v101
    v_rcp_f32 v102, v102
    v_rcp_f32 v103, v103
    v_fma_f32 v100, v100, -2.0, 1.0
    v_fma_f32 v101, v101, -2.0, 1.0
    v_fma_f32 v102, v102, -2.0, 1.0
    v_fma_f32 v103, v103, -2.0, 1.0
    v_cvt_pk_bf16_f32 v106, v100, v101
    v_cvt_pk_bf16_f32 v107, v102, v103
    ds_write_b128 v20, v[104:107] offset:1056
    v_add_f32 v96, v88, v80
    v_add_f32 v97, v89, v81
    v_add_f32 v98, v90, v82
    v_add_f32 v99, v91, v83
    v_add_f32 v100, v92, v84
    v_add_f32 v101, v93, v85
    v_add_f32 v102, v94, v86
    v_add_f32 v103, v95, v87
    ds_read_b128 v[88:91], v50
    ds_read_b128 v[92:95], v50 offset:512
    v_add_u32 v50, 4160, v50
    v_exp_f32 v96, v96
    v_exp_f32 v97, v97
    v_exp_f32 v98, v98
    v_exp_f32 v99, v99
    v_add_f32 v96, 1.0, v96
    v_add_f32 v97, 1.0, v97
    v_add_f32 v98, 1.0, v98
    v_add_f32 v99, 1.0, v99
    v_rcp_f32 v96, v96
    v_rcp_f32 v97, v97
    v_rcp_f32 v98, v98
    v_rcp_f32 v99, v99
    v_fma_f32 v96, v96, -2.0, 1.0
    v_fma_f32 v97, v97, -2.0, 1.0
    v_fma_f32 v98, v98, -2.0, 1.0
    v_fma_f32 v99, v99, -2.0, 1.0
    v_cvt_pk_bf16_f32 v104, v96, v97
    v_cvt_pk_bf16_f32 v105, v98, v99
    v_exp_f32 v100, v100
    v_exp_f32 v101, v101
    v_exp_f32 v102, v102
    v_exp_f32 v103, v103
    v_add_f32 v100, 1.0, v100
    v_add_f32 v101, 1.0, v101
    v_add_f32 v102, 1.0, v102
    v_add_f32 v103, 1.0, v103
    v_rcp_f32 v100, v100
    v_rcp_f32 v101, v101
    v_rcp_f32 v102, v102
    v_rcp_f32 v103, v103
    v_fma_f32 v100, v100, -2.0, 1.0
    v_fma_f32 v101, v101, -2.0, 1.0
    v_fma_f32 v102, v102, -2.0, 1.0
    v_fma_f32 v103, v103, -2.0, 1.0
    v_cvt_pk_bf16_f32 v106, v100, v101
    v_cvt_pk_bf16_f32 v107, v102, v103
    ds_write_b128 v20, v[104:107] offset:1584
    v_add_u32 v20, s51, v20
    s_mov_b32 s66, s49
    s_mov_b32 s49, s50
    s_mov_b32 s50, s51
    s_mov_b32 s51, s66
    s_sub_u32 s68, s68, 1
    s_cmp_lg_u32 s68, 0
    s_waitcnt lgkmcnt(0)
    s_barrier
    s_cbranch_scc1 L_c_loops
    s_endpgm
L_h_slow:
    s_nop 7
    s_barrier
    ds_write_b128 v25, v[112:115]
    ds_write_b128 v25, v[116:119] offset:64
    s_waitcnt lgkmcnt(0)
    s_barrier
    s_mov_b32 s49, 16896
    s_mov_b32 s50, 93216
    s_mov_b32 s51, 4294857184
    ds_read_b128 v[40:43], v27
    ds_read_b128 v[44:47], v27 offset:512
    ds_read_b128 v[48:51], v27 offset:1024
    ds_read_b128 v[52:55], v27 offset:1536
    ds_read_b128 v[56:59], v26
    ds_read_b128 v[60:63], v26 offset:512
    v_add_u32 v26, 4160, v26
    s_waitcnt lgkmcnt(1)
    v_add_f32 v64, v56, v40
    v_add_f32 v65, v57, v41
    v_add_f32 v66, v58, v42
    v_add_f32 v67, v59, v43
    s_waitcnt lgkmcnt(0)
    v_add_f32 v68, v60, v44
    v_add_f32 v69, v61, v45
    v_add_f32 v70, v62, v46
    v_add_f32 v71, v63, v47
    v_exp_f32 v64, v64
    v_exp_f32 v65, v65
    v_exp_f32 v66, v66
    v_exp_f32 v67, v67
    v_add_f32 v64, 1.0, v64
    v_add_f32 v65, 1.0, v65
    v_add_f32 v66, 1.0, v66
    v_add_f32 v67, 1.0, v67
    v_rcp_f32 v64, v64
    v_rcp_f32 v65, v65
    v_rcp_f32 v66, v66
    v_rcp_f32 v67, v67
    v_fma_f32 v64, v64, -2.0, 1.0
    v_fma_f32 v65, v65, -2.0, 1.0
    v_fma_f32 v66, v66, -2.0, 1.0
    v_fma_f32 v67, v67, -2.0, 1.0
    v_cvt_pk_bf16_f32 v72, v64, v65
    v_cvt_pk_bf16_f32 v73, v66, v67
    v_exp_f32 v68, v68
    v_exp_f32 v69, v69
    v_exp_f32 v70, v70
    v_exp_f32 v71, v71
    v_add_f32 v68, 1.0, v68
    v_add_f32 v69, 1.0, v69
    v_add_f32 v70, 1.0, v70
    v_add_f32 v71, 1.0, v71
    v_rcp_f32 v68, v68
    v_rcp_f32 v69, v69
    v_rcp_f32 v70, v70
    v_rcp_f32 v71, v71
    v_fma_f32 v68, v68, -2.0, 1.0
    v_fma_f32 v69, v69, -2.0, 1.0
    v_fma_f32 v70, v70, -2.0, 1.0
    v_fma_f32 v71, v71, -2.0, 1.0
    v_cvt_pk_bf16_f32 v74, v68, v69
    v_cvt_pk_bf16_f32 v75, v70, v71
    ds_write_b128 v33, v[72:75]
    v_add_f32 v64, v56, v48
    v_add_f32 v65, v57, v49
    v_add_f32 v66, v58, v50
    v_add_f32 v67, v59, v51
    v_add_f32 v68, v60, v52
    v_add_f32 v69, v61, v53
    v_add_f32 v70, v62, v54
    v_add_f32 v71, v63, v55
    ds_read_b128 v[56:59], v26
    ds_read_b128 v[60:63], v26 offset:512
    v_add_u32 v26, 4160, v26
    v_exp_f32 v64, v64
    v_exp_f32 v65, v65
    v_exp_f32 v66, v66
    v_exp_f32 v67, v67
    v_add_f32 v64, 1.0, v64
    v_add_f32 v65, 1.0, v65
    v_add_f32 v66, 1.0, v66
    v_add_f32 v67, 1.0, v67
    v_rcp_f32 v64, v64
    v_rcp_f32 v65, v65
    v_rcp_f32 v66, v66
    v_rcp_f32 v67, v67
    v_fma_f32 v64, v64, -2.0, 1.0
    v_fma_f32 v65, v65, -2.0, 1.0
    v_fma_f32 v66, v66, -2.0, 1.0
    v_fma_f32 v67, v67, -2.0, 1.0
    v_cvt_pk_bf16_f32 v72, v64, v65
    v_cvt_pk_bf16_f32 v73, v66, v67
    v_exp_f32 v68, v68
    v_exp_f32 v69, v69
    v_exp_f32 v70, v70
    v_exp_f32 v71, v71
    v_add_f32 v68, 1.0, v68
    v_add_f32 v69, 1.0, v69
    v_add_f32 v70, 1.0, v70
    v_add_f32 v71, 1.0, v71
    v_rcp_f32 v68, v68
    v_rcp_f32 v69, v69
    v_rcp_f32 v70, v70
    v_rcp_f32 v71, v71
    v_fma_f32 v68, v68, -2.0, 1.0
    v_fma_f32 v69, v69, -2.0, 1.0
    v_fma_f32 v70, v70, -2.0, 1.0
    v_fma_f32 v71, v71, -2.0, 1.0
    v_cvt_pk_bf16_f32 v74, v68, v69
    v_cvt_pk_bf16_f32 v75, v70, v71
    ds_write_b128 v33, v[72:75] offset:528
    s_waitcnt lgkmcnt(2)
    v_add_f32 v64, v56, v40
    v_add_f32 v65, v57, v41
    v_add_f32 v66, v58, v42
    v_add_f32 v67, v59, v43
    s_waitcnt lgkmcnt(1)
    v_add_f32 v68, v60, v44
    v_add_f32 v69, v61, v45
    v_add_f32 v70, v62, v46
    v_add_f32 v71, v63, v47
    v_exp_f32 v64, v64
    v_exp_f32 v65, v65
    v_exp_f32 v66, v66
    v_exp_f32 v67, v67
    v_add_f32 v64, 1.0, v64
    v_add_f32 v65, 1.0, v65
    v_add_f32 v66, 1.0, v66
    v_add_f32 v67, 1.0, v67
    v_rcp_f32 v64, v64
    v_rcp_f32 v65, v65
    v_rcp_f32 v66, v66
    v_rcp_f32 v67, v67
    v_fma_f32 v64, v64, -2.0, 1.0
    v_fma_f32 v65, v65, -2.0, 1.0
    v_fma_f32 v66, v66, -2.0, 1.0
    v_fma_f32 v67, v67, -2.0, 1.0
    v_cvt_pk_bf16_f32 v72, v64, v65
    v_cvt_pk_bf16_f32 v73, v66, v67
    v_exp_f32 v68, v68
    v_exp_f32 v69, v69
    v_exp_f32 v70, v70
    v_exp_f32 v71, v71
    v_add_f32 v68, 1.0, v68
    v_add_f32 v69, 1.0, v69
    v_add_f32 v70, 1.0, v70
    v_add_f32 v71, 1.0, v71
    v_rcp_f32 v68, v68
    v_rcp_f32 v69, v69
    v_rcp_f32 v70, v70
    v_rcp_f32 v71, v71
    v_fma_f32 v68, v68, -2.0, 1.0
    v_fma_f32 v69, v69, -2.0, 1.0
    v_fma_f32 v70, v70, -2.0, 1.0
    v_fma_f32 v71, v71, -2.0, 1.0
    v_cvt_pk_bf16_f32 v74, v68, v69
    v_cvt_pk_bf16_f32 v75, v70, v71
    ds_write_b128 v34, v[72:75]
    v_add_f32 v64, v56, v48
    v_add_f32 v65, v57, v49
    v_add_f32 v66, v58, v50
    v_add_f32 v67, v59, v51
    v_add_f32 v68, v60, v52
    v_add_f32 v69, v61, v53
    v_add_f32 v70, v62, v54
    v_add_f32 v71, v63, v55
    ds_read_b128 v[56:59], v26
    ds_read_b128 v[60:63], v26 offset:512
    v_add_u32 v26, 4160, v26
    v_exp_f32 v64, v64
    v_exp_f32 v65, v65
    v_exp_f32 v66, v66
    v_exp_f32 v67, v67
    v_add_f32 v64, 1.0, v64
    v_add_f32 v65, 1.0, v65
    v_add_f32 v66, 1.0, v66
    v_add_f32 v67, 1.0, v67
    v_rcp_f32 v64, v64
    v_rcp_f32 v65, v65
    v_rcp_f32 v66, v66
    v_rcp_f32 v67, v67
    v_fma_f32 v64, v64, -2.0, 1.0
    v_fma_f32 v65, v65, -2.0, 1.0
    v_fma_f32 v66, v66, -2.0, 1.0
    v_fma_f32 v67, v67, -2.0, 1.0
    v_cvt_pk_bf16_f32 v72, v64, v65
    v_cvt_pk_bf16_f32 v73, v66, v67
    v_exp_f32 v68, v68
    v_exp_f32 v69, v69
    v_exp_f32 v70, v70
    v_exp_f32 v71, v71
    v_add_f32 v68, 1.0, v68
    v_add_f32 v69, 1.0, v69
    v_add_f32 v70, 1.0, v70
    v_add_f32 v71, 1.0, v71
    v_rcp_f32 v68, v68
    v_rcp_f32 v69, v69
    v_rcp_f32 v70, v70
    v_rcp_f32 v71, v71
    v_fma_f32 v68, v68, -2.0, 1.0
    v_fma_f32 v69, v69, -2.0, 1.0
    v_fma_f32 v70, v70, -2.0, 1.0
    v_fma_f32 v71, v71, -2.0, 1.0
    v_cvt_pk_bf16_f32 v74, v68, v69
    v_cvt_pk_bf16_f32 v75, v70, v71
    ds_write_b128 v34, v[72:75] offset:528
    s_mov_b32 s68, 8
    s_mov_b32 s62, 0x7ff00000
    s_setprio 1
    s_waitcnt lgkmcnt(0)
    s_barrier
    ds_read_b128 v[120:123], v30
    ds_read_b128 v[124:127], v30 offset:32
    ds_read_b128 v[18:21], v30 offset:64
    s_waitcnt lgkmcnt(0)
L_h_loops:
    v_mfma_f32_32x32x16_bf16 v[40:55], a[0:3], v[120:123], 0
    ds_read_b128 v[4:7], v30 offset:96
    v_mfma_f32_32x32x16_bf16 v[56:71], a[4:7], v[120:123], 0
    v_cvt_pk_bf16_f32 v72, v72, v73
    v_cvt_pk_bf16_f32 v73, v74, v75
    v_mfma_f32_32x32x16_bf16 v[40:55], a[8:11], v[124:127], v[40:55]
    ds_read_b128 v[120:123], v30 offset:128
    v_cvt_pk_bf16_f32 v74, v76, v77
    v_cvt_pk_bf16_f32 v75, v78, v79
    v_mfma_f32_32x32x16_bf16 v[56:71], a[12:15], v[124:127], v[56:71]
    ds_write_b128 v36, v[72:75]
    v_cvt_pk_bf16_f32 v76, v80, v81
    v_mfma_f32_32x32x16_bf16 v[40:55], a[16:19], v[18:21], v[40:55]
    ds_read_b128 v[124:127], v30 offset:160
    v_cvt_pk_bf16_f32 v77, v82, v83
    v_cvt_pk_bf16_f32 v78, v84, v85
    v_mfma_f32_32x32x16_bf16 v[56:71], a[20:23], v[18:21], v[56:71]
    v_cvt_pk_bf16_f32 v79, v86, v87
    ds_write_b128 v36, v[76:79] offset:16
    s_waitcnt lgkmcnt(4)
    v_mfma_f32_32x32x16_bf16 v[40:55], a[24:27], v[4:7], v[40:55]
    ds_read_b128 v[18:21], v30 offset:192
    v_cvt_pk_bf16_f32 v80, v88, v89
    v_cvt_pk_bf16_f32 v81, v90, v91
    v_mfma_f32_32x32x16_bf16 v[56:71], a[28:31], v[4:7], v[56:71]
    v_cvt_pk_bf16_f32 v82, v92, v93
    v_cvt_pk_bf16_f32 v83, v94, v95
    s_waitcnt lgkmcnt(4)
    v_mfma_f32_32x32x16_bf16 v[40:55], a[32:35], v[120:123], v[40:55]
    ds_read_b128 v[4:7], v30 offset:224
    ds_write_b128 v36, v[80:83] offset:32
    v_cvt_pk_bf16_f32 v84, v96, v97
    v_mfma_f32_32x32x16_bf16 v[56:71], a[36:39], v[120:123], v[56:71]
    v_cvt_pk_bf16_f32 v85, v98, v99
    v_cvt_pk_bf16_f32 v86, v100, v101
    s_waitcnt lgkmcnt(4)
    v_mfma_f32_32x32x16_bf16 v[40:55], a[40:43], v[124:127], v[40:55]
    ds_read_b128 v[120:123], v30 offset:256
    v_cvt_pk_bf16_f32 v87, v102, v103
    ds_write_b128 v36, v[84:87] offset:48
    v_mfma_f32_32x32x16_bf16 v[56:71], a[44:47], v[124:127], v[56:71]
    ds_read_b128 v[88:91], v28
    s_waitcnt lgkmcnt(5)
    v_mfma_f32_32x32x16_bf16 v[40:55], a[48:51], v[18:21], v[40:55]
    ds_read_b128 v[124:127], v30 offset:288
    ds_read_b128 v[92:95], v28 offset:1152
    v_mfma_f32_32x32x16_bf16 v[56:71], a[52:55], v[18:21], v[56:71]
    ds_read_b128 v[96:99], v28 offset:2304
    s_waitcnt lgkmcnt(7)
    v_mfma_f32_32x32x16_bf16 v[40:55], a[56:59], v[4:7], v[40:55]
    ds_read_b128 v[18:21], v30 offset:320
    ds_read_b128 v[100:103], v28 offset:3456
    v_mfma_f32_32x32x16_bf16 v[56:71], a[60:63], v[4:7], v[56:71]
    s_waitcnt lgkmcnt(5)
    buffer_store_dwordx4 v[88:91], v29, s[36:39], s62 offen sc0 sc1 nt
    s_add_u32 s62, s62, 4096
    v_mfma_f32_32x32x16_bf16 v[40:55], a[64:67], v[120:123], v[40:55]
    ds_read_b128 v[4:7], v30 offset:352
    v_mfma_f32_32x32x16_bf16 v[56:71], a[68:71], v[120:123], v[56:71]
    s_waitcnt lgkmcnt(5)
    v_mfma_f32_32x32x16_bf16 v[40:55], a[72:75], v[124:127], v[40:55]
    ds_read_b128 v[120:123], v30 offset:384
    v_mfma_f32_32x32x16_bf16 v[56:71], a[76:79], v[124:127], v[56:71]
    s_waitcnt lgkmcnt(5)
    buffer_store_dwordx4 v[92:95], v29, s[36:39], s62 offen sc0 sc1 nt
    s_add_u32 s62, s62, 4096
    s_waitcnt lgkmcnt(3)
    v_mfma_f32_32x32x16_bf16 v[40:55], a[80:83], v[18:21], v[40:55]
    ds_read_b128 v[124:127], v30 offset:416
    v_mfma_f32_32x32x16_bf16 v[56:71], a[84:87], v[18:21], v[56:71]
    s_waitcnt lgkmcnt(2)
    v_mfma_f32_32x32x16_bf16 v[40:55], a[88:91], v[4:7], v[40:55]
    ds_read_b128 v[18:21], v30 offset:448
    v_mfma_f32_32x32x16_bf16 v[56:71], a[92:95], v[4:7], v[56:71]
    buffer_store_dwordx4 v[96:99], v29, s[36:39], s62 offen sc0 sc1 nt
    s_add_u32 s62, s62, 4096
    s_waitcnt lgkmcnt(2)
    v_mfma_f32_32x32x16_bf16 v[40:55], v[128:131], v[120:123], v[40:55]
    ds_read_b128 v[4:7], v30 offset:480
    v_mfma_f32_32x32x16_bf16 v[56:71], v[132:135], v[120:123], v[56:71]
    s_waitcnt lgkmcnt(2)
    v_mfma_f32_32x32x16_bf16 v[40:55], v[136:139], v[124:127], v[40:55]
    ds_read_b128 v[120:123], v31
    v_mfma_f32_32x32x16_bf16 v[56:71], v[140:143], v[124:127], v[56:71]
    buffer_store_dwordx4 v[100:103], v29, s[36:39], s62 offen sc0 sc1 nt
    s_add_u32 s62, s62, 4096
    s_waitcnt lgkmcnt(2)
    v_mfma_f32_32x32x16_bf16 v[40:55], v[144:147], v[18:21], v[40:55]
    ds_read_b128 v[124:127], v31 offset:32
    v_mfma_f32_32x32x16_bf16 v[56:71], v[148:151], v[18:21], v[56:71]
    s_waitcnt lgkmcnt(2)
    v_mfma_f32_32x32x16_bf16 v[72:87], v[152:155], v[4:7], v[40:55]
    ds_read_b128 v[18:21], v31 offset:64
    v_mfma_f32_32x32x16_bf16 v[88:103], v[156:159], v[4:7], v[56:71]
    v_mov_b32 v30, v31
    v_add_u32 v31, s50, v31
    s_mov_b32 s66, s49
    s_mov_b32 s49, s50
    s_mov_b32 s50, s51
    s_mov_b32 s51, s66
    s_cmp_eq_u32 s68, 8
    s_cselect_b32 s62, s63, s62
    s_sub_u32 s68, s68, 1
    s_cmp_lg_u32 s68, 0
    s_waitcnt lgkmcnt(0)
    s_barrier
    s_cbranch_scc1 L_h_loops
    v_cvt_pk_bf16_f32 v72, v72, v73
    v_cvt_pk_bf16_f32 v73, v74, v75
    v_cvt_pk_bf16_f32 v74, v76, v77
    v_cvt_pk_bf16_f32 v75, v78, v79
    ds_write_b128 v36, v[72:75]
    v_cvt_pk_bf16_f32 v76, v80, v81
    v_cvt_pk_bf16_f32 v77, v82, v83
    v_cvt_pk_bf16_f32 v78, v84, v85
    v_cvt_pk_bf16_f32 v79, v86, v87
    ds_write_b128 v36, v[76:79] offset:16
    v_cvt_pk_bf16_f32 v80, v88, v89
    v_cvt_pk_bf16_f32 v81, v90, v91
    v_cvt_pk_bf16_f32 v82, v92, v93
    v_cvt_pk_bf16_f32 v83, v94, v95
    ds_write_b128 v36, v[80:83] offset:32
    v_cvt_pk_bf16_f32 v84, v96, v97
    v_cvt_pk_bf16_f32 v85, v98, v99
    v_cvt_pk_bf16_f32 v86, v100, v101
    v_cvt_pk_bf16_f32 v87, v102, v103
    ds_write_b128 v36, v[84:87] offset:48
    ds_read_b128 v[88:91], v28
    ds_read_b128 v[92:95], v28 offset:1152
    ds_read_b128 v[96:99], v28 offset:2304
    ds_read_b128 v[100:103], v28 offset:3456
    s_waitcnt lgkmcnt(3)
    buffer_store_dwordx4 v[88:91], v29, s[36:39], s62 offen sc0 sc1 nt
    s_add_u32 s62, s62, 4096
    s_waitcnt lgkmcnt(2)
    buffer_store_dwordx4 v[92:95], v29, s[36:39], s62 offen sc0 sc1 nt
    s_add_u32 s62, s62, 4096
    s_waitcnt lgkmcnt(1)
    buffer_store_dwordx4 v[96:99], v29, s[36:39], s62 offen sc0 sc1 nt
    s_add_u32 s62, s62, 4096
    s_waitcnt lgkmcnt(0)
    buffer_store_dwordx4 v[100:103], v29, s[36:39], s62 offen sc0 sc1 nt
    s_add_u32 s62, s62, 4096
L_end:
    s_endpgm
.section .rodata,"a"
.p2align 6
.amdhsa_kernel standalone__seq2seq_rnn_t_joint__speech_kernel
  .amdhsa_next_free_vgpr 256
  .amdhsa_next_free_sgpr 102
  .amdhsa_accum_offset 160
  .amdhsa_group_segment_fixed_size 0
  .amdhsa_kernarg_size 80
  .amdhsa_user_sgpr_count 2
  .amdhsa_user_sgpr_kernarg_segment_ptr 1
  .amdhsa_system_sgpr_workgroup_id_x 1
.end_amdhsa_kernel
```
